```python
import torch

def _softmax(x, axis=-1):
    return torch.softmax(x, dim=axis)
def _gelu(x):
    return torch.nn.functional.gelu(x, approximate="tanh")
def _silu(x):
    return torch.nn.functional.silu(x)
def _sigmoid(x):
    return torch.sigmoid(x)
def _layernorm(x, axis=-1, eps=1e-5):
    m = x.mean(dim=axis, keepdim=True)
    v = x.var(dim=axis, keepdim=True, unbiased=False)
    return (x - m) / torch.sqrt(v + eps)
def _scatter_add(tgt, idx, src, axis=0):
    return tgt.clone().index_add_(axis, idx, src)
def _segment_sum(src, seg, n):
    out = torch.zeros((n,) + src.shape[1:], dtype=src.dtype)
    return out.index_add_(0, seg, src)
def _pad(x, pw):
    flat = tuple(v for pair in reversed(pw) for v in pair)
    return torch.nn.functional.pad(x, flat)

kernel_name = 'interleave_layers__gqa_block_cached__glu_gated_reglu__decode'

def setup_inputs():

    _w = (lambda a: (lambda t: t.to(torch.bfloat16) if t.is_floating_point() else t)(torch.as_tensor(a)))
    def _A_setup():
        B, Sq, D = 4, 1, 512
        Hq, Hkv, Sk, Dh = 32, 8, 8192, 128
        assert Hq % Hkv == 0, (Hq, Hkv)
        return {
            "x": _w((lambda *s: torch.randn(*s, dtype=torch.bfloat16) * 0.05)(B, Sq, D)),
            "k_cache": _w((lambda *s: torch.randn(*s, dtype=torch.bfloat16) * 1.6)(B, Hkv, Sk, Dh)),
            "v_cache": _w((lambda *s: torch.randn(*s, dtype=torch.bfloat16) * 0.8)(B, Hkv, Sk, Dh)),
            "wq": _w((lambda *s: torch.randn(*s, dtype=torch.bfloat16) * 1.6)(D, Hq * Dh) * (D ** -0.5)),
            "wo": _w((lambda *s: torch.randn(*s, dtype=torch.bfloat16) * 0.8)(Hq * Dh, D) * ((Hq * Dh) ** -0.5)),
        }
    _A_in = _A_setup()

    def _B_setup():
        B, S, D, F = 4, 1, 512, 1792
        return {
            "x": _w((lambda *s: torch.randn(*s, dtype=torch.bfloat16) * 0.05)(B, S, D)),
            "W_gate": _w((lambda *s: torch.randn(*s, dtype=torch.bfloat16) * 0.4)(D, F) * (2.0 / D) ** 0.5),
            "W_up": _w((lambda *s: torch.randn(*s, dtype=torch.bfloat16) * 0.4)(D, F) * (2.0 / D) ** 0.5),
            "W_down": _w((lambda *s: torch.randn(*s, dtype=torch.bfloat16) * 0.4)(F, D) * (1.0 / F) ** 0.5),
        }
    _B_in = _B_setup()

    return {
        "A_x": _A_in["x"],
        "A_k_cache": _A_in["k_cache"],
        "A_v_cache": _A_in["v_cache"],
        "A_wq": _A_in["wq"],
        "A_wo": _A_in["wo"],
        "B_x": _B_in["x"],
        "B_W_gate": _B_in["W_gate"],
        "B_W_up": _B_in["W_up"],
        "B_W_down": _B_in["W_down"],
    }

def reference(A_x, A_k_cache, A_v_cache, A_wq, A_wo, B_x, B_W_gate, B_W_up, B_W_down):
    def _A_ref(x, k_cache, v_cache, wq, wo):
        B, Sq, D = x.shape
        Hq, Dh = 32, 128
        Hkv = k_cache.shape[1]
        rep = Hq // Hkv
        q = (lambda x, *d: x.permute(*d))((x @ wq).reshape(B, Sq, Hq, Dh), 0, 2, 1, 3)
        k = (lambda x, n, axis: torch.repeat_interleave(x, n, dim=axis))(k_cache, rep, axis=1)
        v = (lambda x, n, axis: torch.repeat_interleave(x, n, dim=axis))(v_cache, rep, axis=1)
        scores = torch.einsum("bhqd,bhkd->bhqk", q, k) * (Dh ** -0.5)
        p = _softmax(scores, axis=-1)
        o = torch.einsum("bhqk,bhkd->bhqd", p, v)
        return (lambda x, *d: x.permute(*d))(o, 0, 2, 1, 3).reshape(B, Sq, Hq * Dh) @ wo

    def _B_ref(x, W_gate, W_up, W_down):
        gate = torch.einsum("bsd,df->bsf", x, W_gate)
        up = torch.einsum("bsd,df->bsf", x, W_up)
        gate = gate * (lambda x, dt: x.to(dt))(gate > 0, gate.dtype)
        h = gate * up
        return torch.einsum("bsf,fd->bsd", h, W_down)

    x = A_x
    x = x + _A_ref(_layernorm(x, axis=-1), A_k_cache, A_v_cache, A_wq, A_wo)
    x = x + _B_ref(_layernorm(x, axis=-1), B_W_gate, B_W_up, B_W_down)
    x = x + _A_ref(_layernorm(x, axis=-1), A_k_cache, A_v_cache, A_wq, A_wo)
    x = x + _B_ref(_layernorm(x, axis=-1), B_W_gate, B_W_up, B_W_down)
    return x
```

```asm
; @launch grid=(256,1,1) block=(256,1,1) lds=163840
.amdgcn_target "amdgcn-amd-amdhsa--gfx950"
.text
.globl interleave_layers__gqa_block_cached__glu_gated_reglu__decode_kernel
.p2align 8
.type interleave_layers__gqa_block_cached__glu_gated_reglu__decode_kernel,@function
interleave_layers__gqa_block_cached__glu_gated_reglu__decode_kernel:
    s_cmp_ge_u32 s2, 256
    s_cbranch_scc1 L_END
    s_load_dwordx16 s[64:79], s[0:1], 0
    s_load_dwordx8 s[80:87], s[0:1], 64
    v_lshrrev_b32 v1, 6, v0
    v_and_b32 v0, 63, v0
    s_and_b32 s4, s2, 7
    v_readfirstlane_b32 s3, v1
    s_lshr_b32 s5, s2, 3
    s_and_b32 s7, s5, 7
    s_lshr_b32 s6, s5, 3
    v_lshrrev_b32 v11, 4, v0
    v_and_b32 v10, 15, v0
    v_xor_b32 v10, v10, v11
    v_lshlrev_b32 v1, 8, v11
    v_lshl_add_u32 v1, v10, 4, v1
    s_lshl_b32 s32, s6, 3
    s_add_u32 s32, s32, s4
    s_lshl_b32 s32, s32, 21
    s_bfe_u32 s33, s7, 65536
    s_lshl_b32 s33, s33, 14
    s_or_b32 s32, s32, s33
    s_bfe_u32 s33, s7, 65537
    s_lshl_b32 s33, s33, 15
    s_or_b32 s32, s32, s33
    s_bfe_u32 s33, s7, 65538
    s_lshl_b32 s33, s33, 16
    s_or_b32 s32, s32, s33
    s_bfe_u32 s33, s3, 65536
    s_lshl_b32 s33, s33, 12
    s_or_b32 s32, s32, s33
    s_bfe_u32 s33, s3, 65537
    s_lshl_b32 s33, s33, 13
    s_or_b32 s32, s32, s33
    s_lshl_b32 s34, s3, 15
    s_mov_b32 s10, 0x4000000
    s_mov_b32 s11, 0x20000
    s_mov_b32 s14, 0x4000000
    s_mov_b32 s15, 0x20000
    s_lshl_b32 s35, s4, 18
    s_mov_b32 s18, 2097152
    s_mov_b32 s19, 0x20000
    v_lshrrev_b32 v11, 3, v0
    v_lshlrev_b32 v2, 8, v11
    v_and_b32 v11, 6, v11
    v_and_b32 v10, 7, v0
    v_xor_b32 v11, v11, v10
    v_lshl_add_u32 v2, v11, 4, v2
    s_waitcnt lgkmcnt(0)
    s_mov_b32 s8, s66
    s_and_b32 s9, s67, 0xffff
    s_mov_b32 s16, s86
    s_and_b32 s17, s87, 0xffff
    s_cmp_ge_u32 s5, 27
    s_cbranch_scc1 Lclr_1
    v_mov_b32 v48, -1
    v_mov_b32 v49, -1
    v_mov_b32 v50, -1
    v_mov_b32 v51, -1
    v_lshlrev_b32 v11, 4, v0
    s_lshl_b32 s33, s5, 12
    s_add_u32 s33, s33, s35
    s_lshl_b32 s46, s3, 10
    s_add_u32 s33, s33, s46
    buffer_store_dwordx4 v[48:51], v11, s[16:19], s33 offen offset:0 sc1
Lclr_1:
    s_add_u32 m0, s34, 0
    s_xor_b32 s33, s32, 0
    buffer_load_dwordx4 v1, s[8:11], s33 offen offset:0 nt lds
    v_xor_b32 v7, 64, v1
    buffer_load_dwordx4 v7, s[8:11], s33 offen offset:1024 nt lds
    v_xor_b32 v7, 128, v1
    buffer_load_dwordx4 v7, s[8:11], s33 offen offset:2048 nt lds
    v_xor_b32 v7, 192, v1
    buffer_load_dwordx4 v7, s[8:11], s33 offen offset:3072 nt lds
    s_add_u32 m0, s34, 20480
    s_xor_b32 s33, s32, 135168
    buffer_load_dwordx4 v1, s[8:11], s33 offen offset:0 nt lds
    v_xor_b32 v7, 64, v1
    buffer_load_dwordx4 v7, s[8:11], s33 offen offset:1024 nt lds
    v_xor_b32 v7, 128, v1
    buffer_load_dwordx4 v7, s[8:11], s33 offen offset:2048 nt lds
    v_xor_b32 v7, 192, v1
    buffer_load_dwordx4 v7, s[8:11], s33 offen offset:3072 nt lds
    s_mov_b32 s12, s68
    s_and_b32 s13, s69, 0xffff
    s_xor_b32 s33, s32, 0
    s_add_u32 m0, s34, 16384
    s_nop 0
    buffer_load_dwordx4 v2, s[12:15], s33 offen offset:0 nt lds
    s_add_u32 m0, s34, 17280
    s_nop 0
    buffer_load_dwordx4 v2, s[12:15], s33 offen offset:128 nt lds
    s_add_u32 m0, s34, 16384
    s_nop 0
    buffer_load_dwordx4 v2, s[12:15], s33 offen offset:2048 nt lds
    s_add_u32 m0, s34, 17280
    s_nop 0
    buffer_load_dwordx4 v2, s[12:15], s33 offen offset:2176 nt lds
    s_mov_b32 s12, s68
    s_and_b32 s13, s69, 0xffff
    s_mov_b32 s20, s64
    s_and_b32 s21, s65, 0xffff
    s_mov_b32 s22, 4096
    s_mov_b32 s23, 0x20000
    s_mov_b32 s24, s84
    s_and_b32 s25, s85, 0xffff
    s_mov_b32 s26, 256
    s_mov_b32 s27, 0x20000
    s_mov_b32 s28, s82
    s_and_b32 s29, s83, 0xffff
    s_mov_b32 s30, 4096
    s_mov_b32 s31, 0x20000
    s_mov_b32 s38, 0x000f000f
    s_mov_b32 s39, 0x000f000f
    s_mov_b32 s37, 0
    s_mov_b32 s42, 0
    s_mov_b32 s43, 2097152
    s_mov_b32 s44, 0x3f803f80
    s_mov_b32 s45, 0x3e0293ee
    s_mov_b32 s36, 0
    s_mov_b64 s[0:1], -1
    s_sub_u32 s74, s5, 12
    s_cmp_lt_u32 s74, 4
    s_cselect_b32 s33, 1, 0
    s_sub_u32 s74, s5, 4
    s_cmp_lt_u32 s5, 12
    s_cselect_b32 s74, s5, s74
    s_cmp_eq_u32 s33, 1
    s_cselect_b32 s74, 28, s74
    v_lshrrev_b32 v11, 5, v0
    v_lshlrev_b32 v3, 11, v11
    v_bfe_u32 v11, v0, 2, 3
    v_lshl_add_u32 v3, v11, 7, v3
    v_bfe_u32 v11, v0, 3, 2
    v_lshl_add_u32 v3, v11, 5, v3
    v_and_b32 v11, 3, v0
    v_lshl_add_u32 v3, v11, 3, v3
    v_add_u32 v3, s34, v3
    v_xor_b32 v4, 32, v3
    v_xor_b32 v5, 64, v3
    v_xor_b32 v6, 96, v3
    v_and_b32 v10, 15, v0
    v_lshrrev_b32 v11, 4, v0
    v_lshlrev_b32 v8, 4, v10
    v_lshl_add_u32 v8, v11, 6, v8
    v_xor_b32 v11, v11, v10
    v_lshlrev_b32 v9, 8, v10
    v_lshl_add_u32 v9, v11, 4, v9
    v_add_u32 v9, s34, v9
    v_cmp_gt_u32 vcc, 4, v10
    v_bfrev_b32 v11, 1
    s_nop 0
    v_cndmask_b32 v8, v11, v8, vcc
    s_cmp_lg_u32 s3, 0
    s_cbranch_scc1 Lx0_2
    s_mov_b32 m0, 154624
    v_lshlrev_b32 v10, 4, v0
    buffer_load_dwordx4 v10, s[20:23], 0 offen offset:0 lds
    buffer_load_dwordx4 v10, s[20:23], 0 offen offset:1024 lds
    buffer_load_dwordx4 v10, s[20:23], 0 offen offset:2048 lds
    buffer_load_dwordx4 v10, s[20:23], 0 offen offset:3072 lds
Lx0_2:
    s_mov_b32 s60, s70
    s_and_b32 s61, s71, 0xffff
    s_mov_b32 s62, 4194304
    s_mov_b32 s63, 0x20000
    v_bfe_u32 v12, v0, 3, 2
    v_lshlrev_b32 v12, 3, v12
    v_lshrrev_b32 v13, 5, v0
    v_lshl_add_u32 v12, v13, 2, v12
    v_bfe_u32 v13, v0, 1, 2
    v_add_u32 v12, v12, v13
    v_lshlrev_b32 v12, 13, v12
    v_and_b32 v13, 1, v0
    v_lshl_add_u32 v12, v13, 4, v12
    s_lshl_b32 s33, s4, 10
    s_lshl_b32 s46, s5, 5
    s_add_u32 s33, s33, s46
    s_lshl_b32 s46, s3, 20
    s_add_u32 s33, s33, s46
    s_lshl_b32 s46, s3, 12
    s_add_u32 m0, s46, 131072
    s_nop 0
    buffer_load_dwordx4 v12, s[60:63], s33 offen  lds
Lz_3:
    s_add_u32 m0, s34, 12288
    s_xor_b32 s33, s32, 270336
    buffer_load_dwordx4 v1, s[8:11], s33 offen offset:0 nt lds
    v_xor_b32 v7, 64, v1
    buffer_load_dwordx4 v7, s[8:11], s33 offen offset:1024 nt lds
    v_xor_b32 v7, 128, v1
    buffer_load_dwordx4 v7, s[8:11], s33 offen offset:2048 nt lds
    v_xor_b32 v7, 192, v1
    buffer_load_dwordx4 v7, s[8:11], s33 offen offset:3072 nt lds
    s_waitcnt vmcnt(17)
    s_barrier
    s_cmp_lg_u32 s3, 3
    s_cbranch_scc1 Larr_4
    s_getreg_b32 s33, hwreg(HW_REG_XCC_ID)
    s_and_b32 s33, s33, 7
    s_lshl_b32 s46, s4, 3
    s_add_u32 s33, s33, s46
    s_lshl_b32 s33, s33, 2
    v_mov_b32 v11, 1
    s_mov_b64 exec, 1
    buffer_atomic_add v11, off, s[24:27], s33 sc1
    s_mov_b64 exec, -1
Larr_4:
    s_mov_b32 s60, s70
    s_and_b32 s61, s71, 0xffff
    s_mov_b32 s62, 4194304
    s_mov_b32 s63, 0x20000
    v_bfe_u32 v12, v0, 3, 2
    v_lshlrev_b32 v12, 3, v12
    v_lshrrev_b32 v13, 5, v0
    v_lshl_add_u32 v12, v13, 2, v12
    v_bfe_u32 v13, v0, 1, 2
    v_add_u32 v12, v12, v13
    v_lshlrev_b32 v12, 13, v12
    v_and_b32 v13, 1, v0
    v_lshl_add_u32 v12, v13, 4, v12
    s_lshl_b32 s33, s4, 10
    s_lshl_b32 s46, s5, 5
    s_add_u32 s33, s33, s46
    s_lshl_b32 s46, s3, 20
    s_add_u32 s33, s33, s46
    s_add_u32 s33, s33, 262144
    s_lshl_b32 s46, s3, 12
    s_add_u32 m0, s46, 132096
    s_nop 0
    buffer_load_dwordx4 v12, s[60:63], s33 offen  lds
Lz_5:
    s_waitcnt vmcnt(14)
    ds_read_b128 a[0:3], v9 offset:0
    v_xor_b32 v7, 64, v9
    ds_read_b128 a[4:7], v7 offset:0
    v_xor_b32 v7, 128, v9
    ds_read_b128 a[8:11], v7 offset:0
    v_xor_b32 v7, 192, v9
    ds_read_b128 a[12:15], v7 offset:0
    s_add_u32 m0, s34, 8192
    s_xor_b32 s33, s32, 405504
    buffer_load_dwordx4 v1, s[8:11], s33 offen offset:0 nt lds
    v_xor_b32 v7, 64, v1
    buffer_load_dwordx4 v7, s[8:11], s33 offen offset:1024 nt lds
    v_xor_b32 v7, 128, v1
    buffer_load_dwordx4 v7, s[8:11], s33 offen offset:2048 nt lds
    v_xor_b32 v7, 192, v1
    buffer_load_dwordx4 v7, s[8:11], s33 offen offset:3072 nt lds
    s_mov_b32 s60, s70
    s_and_b32 s61, s71, 0xffff
    s_mov_b32 s62, 4194304
    s_mov_b32 s63, 0x20000
    v_bfe_u32 v12, v0, 3, 2
    v_lshlrev_b32 v12, 3, v12
    v_lshrrev_b32 v13, 5, v0
    v_lshl_add_u32 v12, v13, 2, v12
    v_bfe_u32 v13, v0, 1, 2
    v_add_u32 v12, v12, v13
    v_lshlrev_b32 v12, 13, v12
    v_and_b32 v13, 1, v0
    v_lshl_add_u32 v12, v13, 4, v12
    s_lshl_b32 s33, s4, 10
    s_lshl_b32 s46, s5, 5
    s_add_u32 s33, s33, s46
    s_lshl_b32 s46, s3, 20
    s_add_u32 s33, s33, s46
    s_add_u32 s33, s33, 524288
    s_lshl_b32 s46, s3, 12
    s_add_u32 m0, s46, 133120
    s_nop 0
    buffer_load_dwordx4 v12, s[60:63], s33 offen  lds
Lz_6:
    s_waitcnt vmcnt(15)
    ds_read_b128 a[16:19], v9 offset:20480
    v_xor_b32 v7, 64, v9
    ds_read_b128 a[20:23], v7 offset:20480
    v_xor_b32 v7, 128, v9
    ds_read_b128 a[24:27], v7 offset:20480
    v_xor_b32 v7, 192, v9
    ds_read_b128 a[28:31], v7 offset:20480
    s_xor_b32 s33, s32, 135168
    s_add_u32 m0, s34, 4096
    s_nop 0
    buffer_load_dwordx4 v2, s[12:15], s33 offen offset:0 nt lds
    s_add_u32 m0, s34, 4992
    s_nop 0
    buffer_load_dwordx4 v2, s[12:15], s33 offen offset:128 nt lds
    s_add_u32 m0, s34, 4096
    s_nop 0
    buffer_load_dwordx4 v2, s[12:15], s33 offen offset:2048 nt lds
    s_add_u32 m0, s34, 4992
    s_nop 0
    buffer_load_dwordx4 v2, s[12:15], s33 offen offset:2176 nt lds
    s_mov_b32 s60, s70
    s_and_b32 s61, s71, 0xffff
    s_mov_b32 s62, 4194304
    s_mov_b32 s63, 0x20000
    v_bfe_u32 v12, v0, 3, 2
    v_lshlrev_b32 v12, 3, v12
    v_lshrrev_b32 v13, 5, v0
    v_lshl_add_u32 v12, v13, 2, v12
    v_bfe_u32 v13, v0, 1, 2
    v_add_u32 v12, v12, v13
    v_lshlrev_b32 v12, 13, v12
    v_and_b32 v13, 1, v0
    v_lshl_add_u32 v12, v13, 4, v12
    s_lshl_b32 s33, s4, 10
    s_lshl_b32 s46, s5, 5
    s_add_u32 s33, s33, s46
    s_lshl_b32 s46, s3, 20
    s_add_u32 s33, s33, s46
    s_add_u32 s33, s33, 786432
    s_lshl_b32 s46, s3, 12
    s_add_u32 m0, s46, 134144
    s_nop 0
    buffer_load_dwordx4 v12, s[60:63], s33 offen  lds
Lz_7:
    s_waitcnt vmcnt(16)
    ds_read_b64_tr_b16 v[96:97], v3 offset:16384
    ds_read_b64_tr_b16 v[100:101], v4 offset:16384
    ds_read_b64_tr_b16 v[104:105], v5 offset:16384
    ds_read_b64_tr_b16 v[108:109], v6 offset:16384
    ds_read_b64_tr_b16 v[112:113], v3 offset:17408
    ds_read_b64_tr_b16 v[116:117], v4 offset:17408
    ds_read_b64_tr_b16 v[120:121], v5 offset:17408
    ds_read_b64_tr_b16 v[124:125], v6 offset:17408
    s_waitcnt lgkmcnt(0)
    s_add_u32 m0, s34, 20480
    s_xor_b32 s33, s32, 540672
    buffer_load_dwordx4 v1, s[8:11], s33 offen offset:0 nt lds
    v_xor_b32 v7, 64, v1
    buffer_load_dwordx4 v7, s[8:11], s33 offen offset:1024 nt lds
    v_xor_b32 v7, 128, v1
    buffer_load_dwordx4 v7, s[8:11], s33 offen offset:2048 nt lds
    v_xor_b32 v7, 192, v1
    buffer_load_dwordx4 v7, s[8:11], s33 offen offset:3072 nt lds
    s_waitcnt vmcnt(15)
    ds_read_b128 a[32:35], v9 offset:12288
    v_xor_b32 v7, 64, v9
    ds_read_b128 a[36:39], v7 offset:12288
    v_xor_b32 v7, 128, v9
    ds_read_b128 a[40:43], v7 offset:12288
    v_xor_b32 v7, 192, v9
    ds_read_b128 a[44:47], v7 offset:12288
    v_lshlrev_b32 v10, 2, v0
    buffer_load_dword v14, v10, s[24:27], 0 offen sc1
    s_add_u32 m0, s34, 16384
    s_xor_b32 s33, s32, 675840
    buffer_load_dwordx4 v1, s[8:11], s33 offen offset:0 nt lds
    v_xor_b32 v7, 64, v1
    buffer_load_dwordx4 v7, s[8:11], s33 offen offset:1024 nt lds
    v_xor_b32 v7, 128, v1
    buffer_load_dwordx4 v7, s[8:11], s33 offen offset:2048 nt lds
    v_xor_b32 v7, 192, v1
    buffer_load_dwordx4 v7, s[8:11], s33 offen offset:3072 nt lds
    s_waitcnt vmcnt(15)
    ds_read_b128 a[48:51], v9 offset:8192
    v_xor_b32 v7, 64, v9
    ds_read_b128 a[52:55], v7 offset:8192
    v_xor_b32 v7, 128, v9
    ds_read_b128 a[56:59], v7 offset:8192
    v_xor_b32 v7, 192, v9
    ds_read_b128 a[60:63], v7 offset:8192
    s_xor_b32 s33, s32, 270336
    s_add_u32 m0, s34, 0
    s_nop 0
    buffer_load_dwordx4 v2, s[12:15], s33 offen offset:0 nt lds
    s_add_u32 m0, s34, 896
    s_nop 0
    buffer_load_dwordx4 v2, s[12:15], s33 offen offset:128 nt lds
    s_add_u32 m0, s34, 0
    s_nop 0
    buffer_load_dwordx4 v2, s[12:15], s33 offen offset:2048 nt lds
    s_add_u32 m0, s34, 896
    s_nop 0
    buffer_load_dwordx4 v2, s[12:15], s33 offen offset:2176 nt lds
    s_waitcnt vmcnt(14)
    ds_read_b64_tr_b16 v[98:99], v3 offset:4096
    ds_read_b64_tr_b16 v[102:103], v4 offset:4096
    ds_read_b64_tr_b16 v[106:107], v5 offset:4096
    ds_read_b64_tr_b16 v[110:111], v6 offset:4096
    ds_read_b64_tr_b16 v[114:115], v3 offset:5120
    ds_read_b64_tr_b16 v[118:119], v4 offset:5120
    ds_read_b64_tr_b16 v[122:123], v5 offset:5120
    ds_read_b64_tr_b16 v[126:127], v6 offset:5120
    s_waitcnt lgkmcnt(0)
    s_add_u32 m0, s34, 12288
    s_xor_b32 s33, s32, 811008
    buffer_load_dwordx4 v1, s[8:11], s33 offen offset:0 nt lds
    v_xor_b32 v7, 64, v1
    buffer_load_dwordx4 v7, s[8:11], s33 offen offset:1024 nt lds
    v_xor_b32 v7, 128, v1
    buffer_load_dwordx4 v7, s[8:11], s33 offen offset:2048 nt lds
    v_xor_b32 v7, 192, v1
    buffer_load_dwordx4 v7, s[8:11], s33 offen offset:3072 nt lds
    s_waitcnt vmcnt(13)
    ds_read_b128 a[64:67], v9 offset:20480
    v_xor_b32 v7, 64, v9
    ds_read_b128 a[68:71], v7 offset:20480
    v_xor_b32 v7, 128, v9
    ds_read_b128 a[72:75], v7 offset:20480
    v_xor_b32 v7, 192, v9
    ds_read_b128 a[76:79], v7 offset:20480
    s_waitcnt vmcnt(12)
Lck_8:
    v_cmp_eq_u32 vcc, 32, v14
    s_lshl_b32 s33, s4, 3
    s_lshr_b64 s[56:57], vcc, s33
    s_and_b32 s33, s56, 0xff
    s_cbranch_scc0 Lcks_10
    s_mov_b32 s36, 1
Lckd_9:
    s_add_u32 m0, s34, 8192
    s_xor_b32 s33, s32, 946176
    buffer_load_dwordx4 v1, s[8:11], s33 offen offset:0 nt lds
    v_xor_b32 v7, 64, v1
    buffer_load_dwordx4 v7, s[8:11], s33 offen offset:1024 nt lds
    v_xor_b32 v7, 128, v1
    buffer_load_dwordx4 v7, s[8:11], s33 offen offset:2048 nt lds
    v_xor_b32 v7, 192, v1
    buffer_load_dwordx4 v7, s[8:11], s33 offen offset:3072 nt lds
    s_cmp_ge_u32 s74, 28
    s_cbranch_scc1 Lz_11
    s_lshl_b32 s46, s74, 4
    s_mul_i32 s33, s4, 448
    s_add_u32 s33, s33, s46
    s_mul_i32 s46, s3, 458752
    s_add_u32 s33, s33, s46
    s_add_u32 s56, s76, s33
    s_addc_u32 s57, s77, 0
    s_add_u32 s58, s78, s33
    s_addc_u32 s59, s79, 0
    v_bfe_u32 v11, v0, 3, 2
    v_lshlrev_b32 v11, 3, v11
    v_lshrrev_b32 v15, 5, v0
    v_lshl_add_u32 v11, v15, 2, v11
    v_bfe_u32 v15, v0, 1, 2
    v_add_u32 v11, v11, v15
    v_mul_u32_u24 v11, 0xe00, v11
    v_and_b32 v15, 1, v0
    v_cmp_eq_u32 vcc, 1, v15
    v_mov_b32 v12, s56
    v_mov_b32 v13, s57
    v_mov_b32 v7, s58
    v_mov_b32 v15, s59
    v_cndmask_b32 v12, v12, v7, vcc
    v_cndmask_b32 v13, v13, v15, vcc
    v_add_co_u32 v12, vcc, v12, v11
    s_lshr_b32 s46, s3, 1
    s_lshl_b32 s46, s46, 15
    s_add_u32 m0, s46, 90112
    v_addc_co_u32 v13, vcc, 0, v13, vcc
    s_and_b32 s46, s3, 1
    s_lshl_b32 s46, s46, 12
    s_add_u32 m0, m0, s46
    s_nop 0
    global_load_lds_dwordx4 v[12:13], off
Lz_11:
    s_waitcnt vmcnt(12)
    ds_read_b128 a[80:83], v9 offset:16384
    v_xor_b32 v7, 64, v9
    ds_read_b128 a[84:87], v7 offset:16384
    v_xor_b32 v7, 128, v9
    ds_read_b128 a[88:91], v7 offset:16384
    v_xor_b32 v7, 192, v9
    ds_read_b128 a[92:95], v7 offset:16384
    s_waitcnt vmcnt(21)
    s_barrier
    s_cmp_lg_u32 s3, 0
    s_cbranch_scc1 Lq1_12
    v_and_b32 v11, 3, v0
    v_lshlrev_b32 v11, 10, v11
    v_bfe_u32 v15, v0, 2, 2
    v_lshl_add_u32 v11, v15, 6, v11
    v_lshrrev_b32 v15, 4, v0
    v_lshl_add_u32 v11, v15, 4, v11
    v_add_u32 v11, 154624, v11
    ds_read_b128 v[16:19], v11 offset:0
    ds_read_b128 v[20:23], v11 offset:256
    ds_read_b128 v[24:27], v11 offset:512
    ds_read_b128 v[28:31], v11 offset:768
    v_lshlrev_b32 v14, 3, v0
    v_add_u32 v14, 131072, v14
    v_mov_b32 v48, s44
    v_mov_b32 v49, s44
    v_mov_b32 v50, s44
    v_mov_b32 v51, s44
    s_waitcnt lgkmcnt(0)
    ds_read_b64_tr_b16 v[64:65], v14 offset:8192
    ds_read_b64_tr_b16 v[66:67], v14 offset:8704
    ds_read_b64_tr_b16 v[68:69], v14 offset:9216
    ds_read_b64_tr_b16 v[70:71], v14 offset:9728
    ds_read_b64_tr_b16 v[72:73], v14 offset:10240
    ds_read_b64_tr_b16 v[74:75], v14 offset:10752
    ds_read_b64_tr_b16 v[76:77], v14 offset:11264
    ds_read_b64_tr_b16 v[78:79], v14 offset:11776
    ds_read_b64_tr_b16 v[80:81], v14 offset:12288
    ds_read_b64_tr_b16 v[82:83], v14 offset:12800
    ds_read_b64_tr_b16 v[84:85], v14 offset:13312
    ds_read_b64_tr_b16 v[86:87], v14 offset:13824
    s_waitcnt lgkmcnt(4)
    ds_read_b64_tr_b16 v[88:89], v14 offset:14336
    ds_read_b64_tr_b16 v[90:91], v14 offset:14848
    ds_read_b64_tr_b16 v[92:93], v14 offset:15360
    ds_read_b64_tr_b16 v[94:95], v14 offset:15872
    s_waitcnt lgkmcnt(0)
    v_mfma_f32_16x16x32_bf16 v[60:63], v[64:67], v[48:51], 0
    v_mfma_f32_16x16x32_bf16 v[60:63], v[68:71], v[48:51], v[60:63]
    v_mfma_f32_16x16x32_bf16 v[60:63], v[72:75], v[48:51], v[60:63]
    v_mfma_f32_16x16x32_bf16 v[60:63], v[76:79], v[48:51], v[60:63]
    v_mfma_f32_16x16x32_bf16 v[60:63], v[80:83], v[48:51], v[60:63]
    v_mfma_f32_16x16x32_bf16 v[60:63], v[84:87], v[48:51], v[60:63]
    v_mfma_f32_16x16x32_bf16 v[60:63], v[88:91], v[48:51], v[60:63]
    v_mfma_f32_16x16x32_bf16 v[60:63], v[92:95], v[48:51], v[60:63]
Lq1_12:
    s_cmp_lg_u32 s3, 0
    s_cbranch_scc1 Lq1_13
    s_waitcnt lgkmcnt(0)
    ds_read_b64_tr_b16 v[64:65], v14 offset:0
    ds_read_b64_tr_b16 v[66:67], v14 offset:512
    ds_read_b64_tr_b16 v[68:69], v14 offset:1024
    ds_read_b64_tr_b16 v[70:71], v14 offset:1536
    ds_read_b64_tr_b16 v[72:73], v14 offset:2048
    ds_read_b64_tr_b16 v[74:75], v14 offset:2560
    ds_read_b64_tr_b16 v[76:77], v14 offset:3072
    ds_read_b64_tr_b16 v[78:79], v14 offset:3584
    ds_read_b64_tr_b16 v[80:81], v14 offset:4096
    ds_read_b64_tr_b16 v[82:83], v14 offset:4608
    ds_read_b64_tr_b16 v[84:85], v14 offset:5120
    ds_read_b64_tr_b16 v[86:87], v14 offset:5632
    s_waitcnt lgkmcnt(4)
    ds_read_b64_tr_b16 v[88:89], v14 offset:6144
    ds_read_b64_tr_b16 v[90:91], v14 offset:6656
    ds_read_b64_tr_b16 v[92:93], v14 offset:7168
    ds_read_b64_tr_b16 v[94:95], v14 offset:7680
    s_waitcnt lgkmcnt(0)
    v_mfma_f32_16x16x32_bf16 v[60:63], v[64:67], v[48:51], v[60:63]
    v_mfma_f32_16x16x32_bf16 v[60:63], v[68:71], v[48:51], v[60:63]
    v_mfma_f32_16x16x32_bf16 v[60:63], v[72:75], v[48:51], v[60:63]
    v_mfma_f32_16x16x32_bf16 v[60:63], v[76:79], v[48:51], v[60:63]
    v_mfma_f32_16x16x32_bf16 v[60:63], v[80:83], v[48:51], v[60:63]
    v_mfma_f32_16x16x32_bf16 v[60:63], v[84:87], v[48:51], v[60:63]
    v_mfma_f32_16x16x32_bf16 v[60:63], v[88:91], v[48:51], v[60:63]
    v_mfma_f32_16x16x32_bf16 v[60:63], v[92:95], v[48:51], v[60:63]
    v_mov_b32 v55, 0x3727c5ac
Lq1_13:
    s_cmp_lg_u32 s3, 0
    s_cbranch_scc1 Lq1_14
    s_waitcnt lgkmcnt(0)
    v_mov_b32 v53, 0
    v_dot2c_f32_bf16 v53, v16, v16
    v_dot2c_f32_bf16 v53, v17, v17
    v_dot2c_f32_bf16 v53, v18, v18
    v_dot2c_f32_bf16 v53, v19, v19
    v_dot2c_f32_bf16 v53, v20, v20
    v_dot2c_f32_bf16 v53, v21, v21
    v_dot2c_f32_bf16 v53, v22, v22
    v_dot2c_f32_bf16 v53, v23, v23
    v_dot2c_f32_bf16 v53, v24, v24
    v_dot2c_f32_bf16 v53, v25, v25
    v_dot2c_f32_bf16 v53, v26, v26
    v_dot2c_f32_bf16 v53, v27, v27
    v_dot2c_f32_bf16 v53, v28, v28
    v_dot2c_f32_bf16 v53, v29, v29
    v_dot2c_f32_bf16 v53, v30, v30
    v_dot2c_f32_bf16 v53, v31, v31
    v_mfma_f32_16x16x32_bf16 v[32:35], v[64:67], v[16:19], 0
    ds_read_b64_tr_b16 v[64:65], v14 offset:8192
    ds_read_b64_tr_b16 v[66:67], v14 offset:8704
    v_mfma_f32_16x16x32_bf16 v[56:59], v[48:51], v[16:19], 0
    v_mfma_f32_16x16x32_bf16 v[36:39], v[68:71], v[16:19], 0
    ds_read_b64_tr_b16 v[68:69], v14 offset:9216
    ds_read_b64_tr_b16 v[70:71], v14 offset:9728
    v_mfma_f32_16x16x32_bf16 v[56:59], v[48:51], v[20:23], v[56:59]
    v_mfma_f32_16x16x32_bf16 v[40:43], v[72:75], v[16:19], 0
    ds_read_b64_tr_b16 v[72:73], v14 offset:10240
    ds_read_b64_tr_b16 v[74:75], v14 offset:10752
    v_mfma_f32_16x16x32_bf16 v[56:59], v[48:51], v[24:27], v[56:59]
    v_mfma_f32_16x16x32_bf16 v[44:47], v[76:79], v[16:19], 0
    ds_read_b64_tr_b16 v[76:77], v14 offset:11264
    ds_read_b64_tr_b16 v[78:79], v14 offset:11776
    v_mfma_f32_16x16x32_bf16 v[56:59], v[48:51], v[28:31], v[56:59]
    v_add_f32_dpp v54, v53, v53 row_shl:4 row_mask:0xf bank_mask:0xf
    v_add_f32_dpp v54, v53, v54 row_shl:8 row_mask:0xf bank_mask:0xf
    v_mfma_f32_16x16x32_bf16 v[32:35], v[80:83], v[20:23], v[32:35]
    ds_read_b64_tr_b16 v[80:81], v14 offset:12288
    ds_read_b64_tr_b16 v[82:83], v14 offset:12800
    v_mfma_f32_16x16x32_bf16 v[36:39], v[84:87], v[20:23], v[36:39]
    ds_read_b64_tr_b16 v[84:85], v14 offset:13312
    ds_read_b64_tr_b16 v[86:87], v14 offset:13824
    v_mfma_f32_16x16x32_bf16 v[40:43], v[88:91], v[20:23], v[40:43]
    ds_read_b64_tr_b16 v[88:89], v14 offset:14336
    ds_read_b64_tr_b16 v[90:91], v14 offset:14848
    v_mfma_f32_16x16x32_bf16 v[44:47], v[92:95], v[20:23], v[44:47]
    s_waitcnt lgkmcnt(12)
    ds_read_b64_tr_b16 v[92:93], v14 offset:15360
    ds_read_b64_tr_b16 v[94:95], v14 offset:15872
    s_waitcnt lgkmcnt(10)
    v_mfma_f32_16x16x32_bf16 v[32:35], v[64:67], v[24:27], v[32:35]
    v_add_f32_dpp v54, v53, v54 row_shl:12 row_mask:0xf bank_mask:0xf
    v_mov_b32 v53, v54
    v_mfma_f32_16x16x32_bf16 v[36:39], v[68:71], v[24:27], v[36:39]
    s_nop 0
    v_permlane16_swap_b32 v54, v53
    v_mfma_f32_16x16x32_bf16 v[40:43], v[72:75], v[24:27], v[40:43]
    v_add_f32 v54, v54, v53
    v_mov_b32 v53, v54
    s_waitcnt lgkmcnt(4)
    v_mfma_f32_16x16x32_bf16 v[44:47], v[76:79], v[24:27], v[44:47]
    s_nop 0
    v_permlane32_swap_b32 v54, v53
    v_mfma_f32_16x16x32_bf16 v[32:35], v[80:83], v[28:31], v[32:35]
    v_add_f32 v54, v54, v53
    v_fmamk_f32 v54, v54, 0x3b000000, v55
    v_mfma_f32_16x16x32_bf16 v[36:39], v[84:87], v[28:31], v[36:39]
    v_add_f32_dpp v52, v56, v56 row_shl:4 row_mask:0xf bank_mask:0xf
    v_add_f32_dpp v52, v56, v52 row_shl:8 row_mask:0xf bank_mask:0xf
    s_waitcnt lgkmcnt(0)
    v_mfma_f32_16x16x32_bf16 v[40:43], v[88:91], v[28:31], v[40:43]
    v_add_f32_dpp v52, v56, v52 row_shl:12 row_mask:0xf bank_mask:0xf
    v_mul_f32 v52, 0x3b000000, v52
    v_mfma_f32_16x16x32_bf16 v[44:47], v[92:95], v[28:31], v[44:47]
    v_fma_f32 v54, -v52, v52, v54
    v_max_f32 v54, v54, v55
    v_rsq_f32 v54, v54
    s_nop 2
    v_add_f32_dpp v48, v36, v32 row_shl:4 row_mask:0xf bank_mask:0xf
    v_add_f32_dpp v49, v37, v33 row_shl:4 row_mask:0xf bank_mask:0xf
    v_add_f32_dpp v50, v38, v34 row_shl:4 row_mask:0xf bank_mask:0xf
    v_add_f32_dpp v51, v39, v35 row_shl:4 row_mask:0xf bank_mask:0xf
    v_add_f32_dpp v48, v40, v48 row_shl:8 row_mask:0xf bank_mask:0xf
    v_add_f32_dpp v49, v41, v49 row_shl:8 row_mask:0xf bank_mask:0xf
    v_add_f32_dpp v50, v42, v50 row_shl:8 row_mask:0xf bank_mask:0xf
    v_add_f32_dpp v51, v43, v51 row_shl:8 row_mask:0xf bank_mask:0xf
    v_add_f32_dpp v48, v44, v48 row_shl:12 row_mask:0xf bank_mask:0xf
    v_add_f32_dpp v49, v45, v49 row_shl:12 row_mask:0xf bank_mask:0xf
    v_add_f32_dpp v50, v46, v50 row_shl:12 row_mask:0xf bank_mask:0xf
    v_add_f32_dpp v51, v47, v51 row_shl:12 row_mask:0xf bank_mask:0xf
    v_pk_fma_f32 v[48:49], v[52:53], v[60:61], v[48:49] op_sel_hi:[0,1,1] neg_lo:[1,0,0] neg_hi:[1,0,0]
    v_pk_fma_f32 v[50:51], v[52:53], v[62:63], v[50:51] op_sel_hi:[0,1,1] neg_lo:[1,0,0] neg_hi:[1,0,0]
    v_pk_mul_f32 v[48:49], v[48:49], v[54:55] op_sel_hi:[1,0]
    v_pk_mul_f32 v[50:51], v[50:51], v[54:55] op_sel_hi:[1,0]
    v_cvt_pk_bf16_f32 v48, v48, v49
    v_cvt_pk_bf16_f32 v49, v50, v51
    v_bfe_u32 v11, v0, 0, 2
    v_lshlrev_b32 v11, 10, v11
    v_bfe_u32 v15, v0, 5, 1
    v_lshl_add_u32 v11, v15, 8, v11
    v_bfe_u32 v15, v0, 4, 1
    v_lshl_add_u32 v11, v15, 3, v11
    s_bfe_u32 s33, s5, 131073
    s_lshl_b32 s33, s33, 6
    s_add_u32 s46, s35, s33
    s_bfe_u32 s33, s5, 65536
    s_lshl_b32 s33, s33, 9
    s_add_u32 s46, s46, s33
    s_bfe_u32 s33, s5, 131075
    s_lshl_b32 s33, s33, 4
    s_add_u32 s46, s46, s33
    s_add_u32 s46, s46, 106496
    s_mov_b64 exec, s[38:39]
    s_cmp_eq_u32 s36, 0
    s_cbranch_scc1 Ls_15
    buffer_store_dwordx2 v[48:49], v11, s[16:19], s46 offen
Ls_16:
    s_mov_b64 exec, -1
Lq1_14:
    s_xor_b32 s33, s32, 405504
    s_add_u32 m0, s34, 4096
    s_nop 0
    buffer_load_dwordx4 v2, s[12:15], s33 offen offset:0 nt lds
    s_add_u32 m0, s34, 4992
    s_nop 0
    buffer_load_dwordx4 v2, s[12:15], s33 offen offset:128 nt lds
    s_add_u32 m0, s34, 4096
    s_nop 0
    buffer_load_dwordx4 v2, s[12:15], s33 offen offset:2048 nt lds
    s_add_u32 m0, s34, 4992
    s_nop 0
    buffer_load_dwordx4 v2, s[12:15], s33 offen offset:2176 nt lds
    s_waitcnt vmcnt(12)
    ds_read_b64_tr_b16 v[128:129], v3 offset:0
    ds_read_b64_tr_b16 v[132:133], v4 offset:0
    ds_read_b64_tr_b16 v[136:137], v5 offset:0
    ds_read_b64_tr_b16 v[140:141], v6 offset:0
    ds_read_b64_tr_b16 v[144:145], v3 offset:1024
    ds_read_b64_tr_b16 v[148:149], v4 offset:1024
    ds_read_b64_tr_b16 v[152:153], v5 offset:1024
    ds_read_b64_tr_b16 v[156:157], v6 offset:1024
    s_waitcnt lgkmcnt(0)
    s_add_u32 m0, s34, 20480
    s_xor_b32 s33, s32, 1052672
    buffer_load_dwordx4 v1, s[8:11], s33 offen offset:0 nt lds
    v_xor_b32 v7, 64, v1
    buffer_load_dwordx4 v7, s[8:11], s33 offen offset:1024 nt lds
    v_xor_b32 v7, 128, v1
    buffer_load_dwordx4 v7, s[8:11], s33 offen offset:2048 nt lds
    v_xor_b32 v7, 192, v1
    buffer_load_dwordx4 v7, s[8:11], s33 offen offset:3072 nt lds
    s_cmp_ge_u32 s74, 28
    s_cbranch_scc1 Lz_17
    s_lshl_b32 s46, s74, 4
    s_mul_i32 s33, s4, 448
    s_add_u32 s33, s33, s46
    s_mul_i32 s46, s3, 458752
    s_add_u32 s33, s33, s46
    s_add_u32 s33, s33, 114688
    s_add_u32 s56, s76, s33
    s_addc_u32 s57, s77, 0
    s_add_u32 s58, s78, s33
    s_addc_u32 s59, s79, 0
    v_bfe_u32 v11, v0, 3, 2
    v_lshlrev_b32 v11, 3, v11
    v_lshrrev_b32 v15, 5, v0
    v_lshl_add_u32 v11, v15, 2, v11
    v_bfe_u32 v15, v0, 1, 2
    v_add_u32 v11, v11, v15
    v_mul_u32_u24 v11, 0xe00, v11
    v_and_b32 v15, 1, v0
    v_cmp_eq_u32 vcc, 1, v15
    v_mov_b32 v12, s56
    v_mov_b32 v13, s57
    v_mov_b32 v7, s58
    v_mov_b32 v15, s59
    v_cndmask_b32 v12, v12, v7, vcc
    v_cndmask_b32 v13, v13, v15, vcc
    v_add_co_u32 v12, vcc, v12, v11
    s_lshr_b32 s46, s3, 1
    s_lshl_b32 s46, s46, 15
    s_add_u32 m0, s46, 91136
    v_addc_co_u32 v13, vcc, 0, v13, vcc
    s_and_b32 s46, s3, 1
    s_lshl_b32 s46, s46, 12
    s_add_u32 m0, m0, s46
    s_nop 0
    global_load_lds_dwordx4 v[12:13], off
Lz_17:
    s_waitcnt vmcnt(12)
    ds_read_b128 a[96:99], v9 offset:12288
    v_xor_b32 v7, 64, v9
    ds_read_b128 a[100:103], v7 offset:12288
    v_xor_b32 v7, 128, v9
    ds_read_b128 a[104:107], v7 offset:12288
    v_xor_b32 v7, 192, v9
    ds_read_b128 a[108:111], v7 offset:12288
    s_add_u32 m0, s34, 16384
    s_xor_b32 s33, s32, 1179648
    buffer_load_dwordx4 v1, s[8:11], s33 offen offset:0 nt lds
    v_xor_b32 v7, 64, v1
    buffer_load_dwordx4 v7, s[8:11], s33 offen offset:1024 nt lds
    v_xor_b32 v7, 128, v1
    buffer_load_dwordx4 v7, s[8:11], s33 offen offset:2048 nt lds
    v_xor_b32 v7, 192, v1
    buffer_load_dwordx4 v7, s[8:11], s33 offen offset:3072 nt lds
    s_waitcnt vmcnt(12)
    ds_read_b128 a[112:115], v9 offset:8192
    v_xor_b32 v7, 64, v9
    ds_read_b128 a[116:119], v7 offset:8192
    v_xor_b32 v7, 128, v9
    ds_read_b128 a[120:123], v7 offset:8192
    v_xor_b32 v7, 192, v9
    ds_read_b128 a[124:127], v7 offset:8192
    s_xor_b32 s33, s32, 540672
    s_add_u32 m0, s34, 0
    s_nop 0
    buffer_load_dwordx4 v2, s[12:15], s33 offen offset:0 nt lds
    s_add_u32 m0, s34, 896
    s_nop 0
    buffer_load_dwordx4 v2, s[12:15], s33 offen offset:128 nt lds
    s_add_u32 m0, s34, 0
    s_nop 0
    buffer_load_dwordx4 v2, s[12:15], s33 offen offset:2048 nt lds
    s_add_u32 m0, s34, 896
    s_nop 0
    buffer_load_dwordx4 v2, s[12:15], s33 offen offset:2176 nt lds
    s_cmp_ge_u32 s74, 28
    s_cbranch_scc1 Lz_18
    s_lshl_b32 s46, s74, 4
    s_mul_i32 s33, s4, 448
    s_add_u32 s33, s33, s46
    s_mul_i32 s46, s3, 458752
    s_add_u32 s33, s33, s46
    s_add_u32 s33, s33, 229376
    s_add_u32 s56, s76, s33
    s_addc_u32 s57, s77, 0
    s_add_u32 s58, s78, s33
    s_addc_u32 s59, s79, 0
    v_bfe_u32 v11, v0, 3, 2
    v_lshlrev_b32 v11, 3, v11
    v_lshrrev_b32 v15, 5, v0
    v_lshl_add_u32 v11, v15, 2, v11
    v_bfe_u32 v15, v0, 1, 2
    v_add_u32 v11, v11, v15
    v_mul_u32_u24 v11, 0xe00, v11
    v_and_b32 v15, 1, v0
    v_cmp_eq_u32 vcc, 1, v15
    v_mov_b32 v12, s56
    v_mov_b32 v13, s57
    v_mov_b32 v7, s58
    v_mov_b32 v15, s59
    v_cndmask_b32 v12, v12, v7, vcc
    v_cndmask_b32 v13, v13, v15, vcc
    v_add_co_u32 v12, vcc, v12, v11
    s_lshr_b32 s46, s3, 1
    s_lshl_b32 s46, s46, 15
    s_add_u32 m0, s46, 92160
    v_addc_co_u32 v13, vcc, 0, v13, vcc
    s_and_b32 s46, s3, 1
    s_lshl_b32 s46, s46, 12
    s_add_u32 m0, m0, s46
    s_nop 0
    global_load_lds_dwordx4 v[12:13], off
Lz_18:
    s_waitcnt vmcnt(12)
    ds_read_b64_tr_b16 v[130:131], v3 offset:4096
    ds_read_b64_tr_b16 v[134:135], v4 offset:4096
    ds_read_b64_tr_b16 v[138:139], v5 offset:4096
    ds_read_b64_tr_b16 v[142:143], v6 offset:4096
    ds_read_b64_tr_b16 v[146:147], v3 offset:5120
    ds_read_b64_tr_b16 v[150:151], v4 offset:5120
    ds_read_b64_tr_b16 v[154:155], v5 offset:5120
    ds_read_b64_tr_b16 v[158:159], v6 offset:5120
    s_waitcnt lgkmcnt(0)
    s_add_u32 m0, s34, 12288
    s_xor_b32 s33, s32, 1323008
    buffer_load_dwordx4 v1, s[8:11], s33 offen offset:0 nt lds
    v_xor_b32 v7, 64, v1
    buffer_load_dwordx4 v7, s[8:11], s33 offen offset:1024 nt lds
    v_xor_b32 v7, 128, v1
    buffer_load_dwordx4 v7, s[8:11], s33 offen offset:2048 nt lds
    v_xor_b32 v7, 192, v1
    buffer_load_dwordx4 v7, s[8:11], s33 offen offset:3072 nt lds
    s_waitcnt vmcnt(12)
    ds_read_b128 a[128:131], v9 offset:20480
    v_xor_b32 v7, 64, v9
    ds_read_b128 a[132:135], v7 offset:20480
    v_xor_b32 v7, 128, v9
    ds_read_b128 a[136:139], v7 offset:20480
    v_xor_b32 v7, 192, v9
    ds_read_b128 a[140:143], v7 offset:20480
    s_add_u32 m0, s34, 8192
    s_xor_b32 s33, s32, 1449984
    buffer_load_dwordx4 v1, s[8:11], s33 offen offset:0 nt lds
    v_xor_b32 v7, 64, v1
    buffer_load_dwordx4 v7, s[8:11], s33 offen offset:1024 nt lds
    v_xor_b32 v7, 128, v1
    buffer_load_dwordx4 v7, s[8:11], s33 offen offset:2048 nt lds
    v_xor_b32 v7, 192, v1
    buffer_load_dwordx4 v7, s[8:11], s33 offen offset:3072 nt lds
    s_cmp_ge_u32 s74, 28
    s_cbranch_scc1 Lz_19
    s_lshl_b32 s46, s74, 4
    s_mul_i32 s33, s4, 448
    s_add_u32 s33, s33, s46
    s_mul_i32 s46, s3, 458752
    s_add_u32 s33, s33, s46
    s_add_u32 s33, s33, 344064
    s_add_u32 s56, s76, s33
    s_addc_u32 s57, s77, 0
    s_add_u32 s58, s78, s33
    s_addc_u32 s59, s79, 0
    v_bfe_u32 v11, v0, 3, 2
    v_lshlrev_b32 v11, 3, v11
    v_lshrrev_b32 v15, 5, v0
    v_lshl_add_u32 v11, v15, 2, v11
    v_bfe_u32 v15, v0, 1, 2
    v_add_u32 v11, v11, v15
    v_mul_u32_u24 v11, 0xe00, v11
    v_and_b32 v15, 1, v0
    v_cmp_eq_u32 vcc, 1, v15
    v_mov_b32 v12, s56
    v_mov_b32 v13, s57
    v_mov_b32 v7, s58
    v_mov_b32 v15, s59
    v_cndmask_b32 v12, v12, v7, vcc
    v_cndmask_b32 v13, v13, v15, vcc
    v_add_co_u32 v12, vcc, v12, v11
    s_lshr_b32 s46, s3, 1
    s_lshl_b32 s46, s46, 15
    s_add_u32 m0, s46, 93184
    v_addc_co_u32 v13, vcc, 0, v13, vcc
    s_and_b32 s46, s3, 1
    s_lshl_b32 s46, s46, 12
    s_add_u32 m0, m0, s46
    s_nop 0
    global_load_lds_dwordx4 v[12:13], off
Lz_19:
    s_waitcnt vmcnt(12)
    ds_read_b128 a[144:147], v9 offset:16384
    v_xor_b32 v7, 64, v9
    ds_read_b128 a[148:151], v7 offset:16384
    v_xor_b32 v7, 128, v9
    ds_read_b128 a[152:155], v7 offset:16384
    v_xor_b32 v7, 192, v9
    ds_read_b128 a[156:159], v7 offset:16384
    s_xor_b32 s33, s32, 675840
    s_add_u32 m0, s34, 4096
    s_nop 0
    buffer_load_dwordx4 v2, s[12:15], s33 offen offset:0 nt lds
    s_add_u32 m0, s34, 4992
    s_nop 0
    buffer_load_dwordx4 v2, s[12:15], s33 offen offset:128 nt lds
    s_add_u32 m0, s34, 4096
    s_nop 0
    buffer_load_dwordx4 v2, s[12:15], s33 offen offset:2048 nt lds
    s_add_u32 m0, s34, 4992
    s_nop 0
    buffer_load_dwordx4 v2, s[12:15], s33 offen offset:2176 nt lds
    s_waitcnt vmcnt(12)
    ds_read_b64_tr_b16 v[160:161], v3 offset:0
    ds_read_b64_tr_b16 v[164:165], v4 offset:0
    ds_read_b64_tr_b16 v[168:169], v5 offset:0
    ds_read_b64_tr_b16 v[172:173], v6 offset:0
    ds_read_b64_tr_b16 v[176:177], v3 offset:1024
    ds_read_b64_tr_b16 v[180:181], v4 offset:1024
    ds_read_b64_tr_b16 v[184:185], v5 offset:1024
    ds_read_b64_tr_b16 v[188:189], v6 offset:1024
    s_waitcnt lgkmcnt(0)
    s_add_u32 m0, s34, 20480
    s_xor_b32 s33, s32, 1593344
    buffer_load_dwordx4 v1, s[8:11], s33 offen offset:0 nt lds
    v_xor_b32 v7, 64, v1
    buffer_load_dwordx4 v7, s[8:11], s33 offen offset:1024 nt lds
    v_xor_b32 v7, 128, v1
    buffer_load_dwordx4 v7, s[8:11], s33 offen offset:2048 nt lds
    v_xor_b32 v7, 192, v1
    buffer_load_dwordx4 v7, s[8:11], s33 offen offset:3072 nt lds
    s_waitcnt vmcnt(12)
    ds_read_b128 a[160:163], v9 offset:12288
    v_xor_b32 v7, 64, v9
    ds_read_b128 a[164:167], v7 offset:12288
    v_xor_b32 v7, 128, v9
    ds_read_b128 a[168:171], v7 offset:12288
    v_xor_b32 v7, 192, v9
    ds_read_b128 a[172:175], v7 offset:12288
    s_add_u32 m0, s34, 16384
    s_xor_b32 s33, s32, 1720320
    buffer_load_dwordx4 v1, s[8:11], s33 offen offset:0 nt lds
    v_xor_b32 v7, 64, v1
    buffer_load_dwordx4 v7, s[8:11], s33 offen offset:1024 nt lds
    v_xor_b32 v7, 128, v1
    buffer_load_dwordx4 v7, s[8:11], s33 offen offset:2048 nt lds
    v_xor_b32 v7, 192, v1
    buffer_load_dwordx4 v7, s[8:11], s33 offen offset:3072 nt lds
    s_waitcnt vmcnt(12)
    ds_read_b128 a[176:179], v9 offset:8192
    v_xor_b32 v7, 64, v9
    ds_read_b128 a[180:183], v7 offset:8192
    v_xor_b32 v7, 128, v9
    ds_read_b128 a[184:187], v7 offset:8192
    v_xor_b32 v7, 192, v9
    ds_read_b128 a[188:191], v7 offset:8192
    s_xor_b32 s33, s32, 1052672
    s_add_u32 m0, s34, 0
    s_nop 0
    buffer_load_dwordx4 v2, s[12:15], s33 offen offset:0 nt lds
    s_add_u32 m0, s34, 896
    s_nop 0
    buffer_load_dwordx4 v2, s[12:15], s33 offen offset:128 nt lds
    s_add_u32 m0, s34, 0
    s_nop 0
    buffer_load_dwordx4 v2, s[12:15], s33 offen offset:2048 nt lds
    s_add_u32 m0, s34, 896
    s_nop 0
    buffer_load_dwordx4 v2, s[12:15], s33 offen offset:2176 nt lds
    s_waitcnt vmcnt(12)
    ds_read_b64_tr_b16 v[162:163], v3 offset:4096
    ds_read_b64_tr_b16 v[166:167], v4 offset:4096
    ds_read_b64_tr_b16 v[170:171], v5 offset:4096
    ds_read_b64_tr_b16 v[174:175], v6 offset:4096
    ds_read_b64_tr_b16 v[178:179], v3 offset:5120
    ds_read_b64_tr_b16 v[182:183], v4 offset:5120
    ds_read_b64_tr_b16 v[186:187], v5 offset:5120
    ds_read_b64_tr_b16 v[190:191], v6 offset:5120
    s_waitcnt lgkmcnt(0)
    s_add_u32 m0, s34, 12288
    s_xor_b32 s33, s32, 1863680
    buffer_load_dwordx4 v1, s[8:11], s33 offen offset:0 nt lds
    v_xor_b32 v7, 64, v1
    buffer_load_dwordx4 v7, s[8:11], s33 offen offset:1024 nt lds
    v_xor_b32 v7, 128, v1
    buffer_load_dwordx4 v7, s[8:11], s33 offen offset:2048 nt lds
    v_xor_b32 v7, 192, v1
    buffer_load_dwordx4 v7, s[8:11], s33 offen offset:3072 nt lds
    s_waitcnt vmcnt(12)
    ds_read_b128 a[192:195], v9 offset:20480
    v_xor_b32 v7, 64, v9
    ds_read_b128 a[196:199], v7 offset:20480
    v_xor_b32 v7, 128, v9
    ds_read_b128 a[200:203], v7 offset:20480
    v_xor_b32 v7, 192, v9
    ds_read_b128 a[204:207], v7 offset:20480
    s_lshl_b32 s47, s6, 10
    s_add_u32 s47, s47, s35
    s_add_u32 s47, s47, 106496
    v_lshlrev_b32 v7, 4, v0
    buffer_load_dwordx4 v[64:67], v7, s[16:19], s47 offen sc1
    s_add_u32 m0, s34, 8192
    s_xor_b32 s33, s32, 1990656
    buffer_load_dwordx4 v1, s[8:11], s33 offen offset:0 nt lds
    v_xor_b32 v7, 64, v1
    buffer_load_dwordx4 v7, s[8:11], s33 offen offset:1024 nt lds
    v_xor_b32 v7, 128, v1
    buffer_load_dwordx4 v7, s[8:11], s33 offen offset:2048 nt lds
    v_xor_b32 v7, 192, v1
    buffer_load_dwordx4 v7, s[8:11], s33 offen offset:3072 nt lds
    s_waitcnt vmcnt(13)
    ds_read_b128 a[208:211], v9 offset:16384
    v_xor_b32 v7, 64, v9
    ds_read_b128 a[212:215], v7 offset:16384
    v_xor_b32 v7, 128, v9
    ds_read_b128 a[216:219], v7 offset:16384
    v_xor_b32 v7, 192, v9
    ds_read_b128 a[220:223], v7 offset:16384
    s_xor_b32 s33, s32, 1179648
    s_add_u32 m0, s34, 4096
    s_nop 0
    buffer_load_dwordx4 v2, s[12:15], s33 offen offset:0 nt lds
    s_add_u32 m0, s34, 4992
    s_nop 0
    buffer_load_dwordx4 v2, s[12:15], s33 offen offset:128 nt lds
    s_add_u32 m0, s34, 4096
    s_nop 0
    buffer_load_dwordx4 v2, s[12:15], s33 offen offset:2048 nt lds
    s_add_u32 m0, s34, 4992
    s_nop 0
    buffer_load_dwordx4 v2, s[12:15], s33 offen offset:2176 nt lds
    s_waitcnt vmcnt(13)
    ds_read_b64_tr_b16 v[192:193], v3 offset:0
    ds_read_b64_tr_b16 v[196:197], v4 offset:0
    ds_read_b64_tr_b16 v[200:201], v5 offset:0
    ds_read_b64_tr_b16 v[204:205], v6 offset:0
    ds_read_b64_tr_b16 v[208:209], v3 offset:1024
    ds_read_b64_tr_b16 v[212:213], v4 offset:1024
    ds_read_b64_tr_b16 v[216:217], v5 offset:1024
    ds_read_b64_tr_b16 v[220:221], v6 offset:1024
    s_waitcnt lgkmcnt(0)
    s_xor_b32 s33, s32, 1593344
    s_add_u32 m0, s34, 20480
    s_nop 0
    buffer_load_dwordx4 v2, s[12:15], s33 offen offset:0 nt lds
    s_add_u32 m0, s34, 21376
    s_nop 0
    buffer_load_dwordx4 v2, s[12:15], s33 offen offset:128 nt lds
    s_add_u32 m0, s34, 20480
    s_nop 0
    buffer_load_dwordx4 v2, s[12:15], s33 offen offset:2048 nt lds
    s_add_u32 m0, s34, 21376
    s_nop 0
    buffer_load_dwordx4 v2, s[12:15], s33 offen offset:2176 nt lds
    s_waitcnt vmcnt(13)
    ds_read_b128 a[224:227], v9 offset:12288
    v_xor_b32 v7, 64, v9
    ds_read_b128 a[228:231], v7 offset:12288
    v_xor_b32 v7, 128, v9
    ds_read_b128 a[232:235], v7 offset:12288
    v_xor_b32 v7, 192, v9
    ds_read_b128 a[236:239], v7 offset:12288
    s_xor_b32 s33, s32, 1720320
    s_add_u32 m0, s34, 16384
    s_nop 0
    buffer_load_dwordx4 v2, s[12:15], s33 offen offset:0 nt lds
    s_add_u32 m0, s34, 17280
    s_nop 0
    buffer_load_dwordx4 v2, s[12:15], s33 offen offset:128 nt lds
    s_add_u32 m0, s34, 16384
    s_nop 0
    buffer_load_dwordx4 v2, s[12:15], s33 offen offset:2048 nt lds
    s_add_u32 m0, s34, 17280
    s_nop 0
    buffer_load_dwordx4 v2, s[12:15], s33 offen offset:2176 nt lds
    s_waitcnt vmcnt(12)
    ds_read_b128 a[240:243], v9 offset:8192
    v_xor_b32 v7, 64, v9
    ds_read_b128 a[244:247], v7 offset:8192
    v_xor_b32 v7, 128, v9
    ds_read_b128 a[248:251], v7 offset:8192
    v_xor_b32 v7, 192, v9
    ds_read_b128 a[252:255], v7 offset:8192
    s_waitcnt vmcnt(16)
    s_waitcnt lgkmcnt(0)
    v_mov_b32 v16, 0
    v_mov_b32 v17, 0
    v_mov_b32 v18, 0
    v_mov_b32 v19, 0
    v_mov_b32 v20, 0
    v_mov_b32 v21, 0
    v_mov_b32 v22, 0
    v_mov_b32 v23, 0
    v_mov_b32 v24, 0
    v_mov_b32 v25, 0
    v_mov_b32 v26, 0
    v_mov_b32 v27, 0
    v_mov_b32 v28, 0
    v_mov_b32 v29, 0
    v_mov_b32 v30, 0
    v_mov_b32 v31, 0
    s_mov_b32 s8, s47
    s_mov_b32 s75, 0
    s_lshl_b32 s33, s6, 9
    s_add_u32 s33, s33, s35
    s_add_u32 s9, s33, 98304
    s_lshl_b32 s33, s7, 2
    s_add_u32 s33, s33, s3
    s_lshl_b32 s33, s33, 4
    s_add_u32 s10, s9, s33
    s_lshl_b32 s33, s6, 14
    s_add_u32 s63, s33, s35
    s_add_u32 s63, s63, 16384
    s_lshl_b32 s33, s7, 11
    s_add_u32 s11, s63, s33
    s_lshl_b32 s33, s3, 9
    s_add_u32 s11, s11, s33
    s_lshl_b32 s33, s7, 8
    s_add_u32 s63, s63, s33
    s_lshl_b32 s33, s6, 2
    s_add_u32 s33, s33, s3
    s_lshl_b32 s33, s33, 5
    s_add_u32 s60, s33, s35
    s_lshl_b32 s33, s7, 2
    s_add_u32 s60, s60, s33
    s_add_u32 s60, s60, 102400
    s_lshr_b32 s33, s7, 1
    s_lshl_b32 s46, s6, 2
    s_add_u32 s33, s33, s46
    s_lshl_b32 s33, s33, 5
    s_add_u32 s33, s33, s35
    s_add_u32 s40, s33, 102400
    s_lshl_b32 s41, s3, 4
    s_add_u32 s41, s41, 154624
    s_lshl_b32 s61, s3, 11
    s_add_u32 s61, s61, 154624
    s_lshl_b32 s62, s3, 2
    s_add_u32 s62, s62, 162816
    v_bfe_u32 v9, v0, 1, 2
    v_lshlrev_b32 v9, 8, v9
    v_bfe_u32 v15, v0, 3, 2
    v_lshl_add_u32 v9, v15, 6, v9
    v_bfe_u32 v15, v0, 5, 1
    v_lshl_add_u32 v9, v15, 10, v9
    v_bfe_u32 v15, v0, 0, 1
    v_lshl_add_u32 v9, v15, 3, v9
    v_add_u32 v9, s41, v9
    v_max3_u32 v11, v64, v65, v66
    v_max_u32 v11, v11, v67
    v_cmp_eq_u32 vcc, -1, v11
    v_mov_b32_dpp v16, v64 quad_perm:[0,1,2,3] row_mask:0xf bank_mask:0x1
    v_mov_b32_dpp v17, v65 quad_perm:[0,1,2,3] row_mask:0xf bank_mask:0x1
    v_mov_b32_dpp v18, v66 quad_perm:[0,1,2,3] row_mask:0xf bank_mask:0x1
    v_mov_b32_dpp v19, v67 quad_perm:[0,1,2,3] row_mask:0xf bank_mask:0x1
    s_and_b64 vcc, vcc, s[0:1]
    s_cbranch_scc1 L_QPOLL0
    s_branch L_QGO
L_QPOLL0:
    v_lshlrev_b32 v10, 4, v0
    s_mov_b32 s75, 1
    s_waitcnt vmcnt(1)
    v_mov_b32 v16, 0
    v_mov_b32 v17, 0
    v_mov_b32 v18, 0
    v_mov_b32 v19, 0
    v_mov_b32 v20, 0
    v_mov_b32 v21, 0
    v_mov_b32 v22, 0
    v_mov_b32 v23, 0
    v_mov_b32 v24, 0
    v_mov_b32 v25, 0
    v_mov_b32 v26, 0
    v_mov_b32 v27, 0
    v_mov_b32 v28, 0
    v_mov_b32 v29, 0
    v_mov_b32 v30, 0
    v_mov_b32 v31, 0
    buffer_load_dwordx4 v[64:67], v10, s[16:19], s8 offen sc1
    s_sleep 1
L_QPOLL:
    buffer_load_dwordx4 v[64:67], v10, s[16:19], s8 offen sc1
    s_sub_u32 s43, s43, 1
    s_cbranch_scc1 Lgu_21
Lpk_20:
    s_waitcnt vmcnt(1)
    v_max3_u32 v11, v64, v65, v66
    v_max_u32 v11, v11, v67
    v_cmp_eq_u32 vcc, -1, v11
    v_mov_b32_dpp v16, v64 quad_perm:[0,1,2,3] row_mask:0xf bank_mask:0x1
    v_mov_b32_dpp v17, v65 quad_perm:[0,1,2,3] row_mask:0xf bank_mask:0x1
    v_mov_b32_dpp v18, v66 quad_perm:[0,1,2,3] row_mask:0xf bank_mask:0x1
    v_mov_b32_dpp v19, v67 quad_perm:[0,1,2,3] row_mask:0xf bank_mask:0x1
    s_and_b64 vcc, vcc, s[0:1]
    s_cbranch_scc1 L_QPOLL
L_QGO:
    v_mfma_f32_16x16x32_bf16 v[48:51], a[0:3], v[16:19], 0
    v_mov_b32_dpp v20, v64 row_shl:4 row_mask:0xf bank_mask:0x1
    v_mov_b32_dpp v21, v65 row_shl:4 row_mask:0xf bank_mask:0x1
    v_mfma_f32_16x16x32_bf16 v[52:55], a[16:19], v[16:19], 0
    v_mov_b32_dpp v22, v66 row_shl:4 row_mask:0xf bank_mask:0x1
    v_mov_b32_dpp v23, v67 row_shl:4 row_mask:0xf bank_mask:0x1
    v_mfma_f32_16x16x32_bf16 v[56:59], a[128:131], v[16:19], 0
    v_mov_b32_dpp v24, v64 row_shl:8 row_mask:0xf bank_mask:0x1
    v_mov_b32_dpp v25, v65 row_shl:8 row_mask:0xf bank_mask:0x1
    v_mfma_f32_16x16x32_bf16 v[60:63], a[144:147], v[16:19], 0
    v_mov_b32_dpp v26, v66 row_shl:8 row_mask:0xf bank_mask:0x1
    v_mov_b32_dpp v27, v67 row_shl:8 row_mask:0xf bank_mask:0x1
    v_mfma_f32_16x16x32_bf16 v[48:51], a[4:7], v[20:23], v[48:51]
    v_mov_b32_dpp v28, v64 row_shl:12 row_mask:0xf bank_mask:0x1
    v_mov_b32_dpp v29, v65 row_shl:12 row_mask:0xf bank_mask:0x1
    v_mfma_f32_16x16x32_bf16 v[52:55], a[20:23], v[20:23], v[52:55]
    v_mov_b32_dpp v30, v66 row_shl:12 row_mask:0xf bank_mask:0x1
    v_mov_b32_dpp v31, v67 row_shl:12 row_mask:0xf bank_mask:0x1
    v_mfma_f32_16x16x32_bf16 v[56:59], a[132:135], v[20:23], v[56:59]
    v_mov_b32_dpp v32, v16 row_shr:4 row_mask:0xf bank_mask:0xf bound_ctrl:0
    v_mov_b32_dpp v33, v17 row_shr:4 row_mask:0xf bank_mask:0xf bound_ctrl:0
    v_mfma_f32_16x16x32_bf16 v[60:63], a[148:151], v[20:23], v[60:63]
    v_mov_b32_dpp v34, v18 row_shr:4 row_mask:0xf bank_mask:0xf bound_ctrl:0
    v_mov_b32_dpp v35, v19 row_shr:4 row_mask:0xf bank_mask:0xf bound_ctrl:0
    v_mfma_f32_16x16x32_bf16 v[48:51], a[8:11], v[24:27], v[48:51]
    v_mov_b32_dpp v36, v20 row_shr:4 row_mask:0xf bank_mask:0xf bound_ctrl:0
    v_mov_b32_dpp v37, v21 row_shr:4 row_mask:0xf bank_mask:0xf bound_ctrl:0
    v_mfma_f32_16x16x32_bf16 v[52:55], a[24:27], v[24:27], v[52:55]
    v_mov_b32_dpp v38, v22 row_shr:4 row_mask:0xf bank_mask:0xf bound_ctrl:0
    v_mov_b32_dpp v39, v23 row_shr:4 row_mask:0xf bank_mask:0xf bound_ctrl:0
    v_mfma_f32_16x16x32_bf16 v[56:59], a[136:139], v[24:27], v[56:59]
    v_mov_b32_dpp v40, v24 row_shr:4 row_mask:0xf bank_mask:0xf bound_ctrl:0
    v_mov_b32_dpp v41, v25 row_shr:4 row_mask:0xf bank_mask:0xf bound_ctrl:0
    v_mfma_f32_16x16x32_bf16 v[60:63], a[152:155], v[24:27], v[60:63]
    v_mov_b32_dpp v42, v26 row_shr:4 row_mask:0xf bank_mask:0xf bound_ctrl:0
    v_mov_b32_dpp v43, v27 row_shr:4 row_mask:0xf bank_mask:0xf bound_ctrl:0
    v_mfma_f32_16x16x32_bf16 v[48:51], a[12:15], v[28:31], v[48:51]
    v_mov_b32_dpp v44, v28 row_shr:4 row_mask:0xf bank_mask:0xf bound_ctrl:0
    v_mov_b32_dpp v45, v29 row_shr:4 row_mask:0xf bank_mask:0xf bound_ctrl:0
    v_mfma_f32_16x16x32_bf16 v[52:55], a[28:31], v[28:31], v[52:55]
    v_mov_b32_dpp v46, v30 row_shr:4 row_mask:0xf bank_mask:0xf bound_ctrl:0
    v_mov_b32_dpp v47, v31 row_shr:4 row_mask:0xf bank_mask:0xf bound_ctrl:0
    v_mfma_f32_16x16x32_bf16 v[56:59], a[140:143], v[28:31], v[56:59]
    v_mfma_f32_16x16x32_bf16 v[60:63], a[156:159], v[28:31], v[60:63]
    s_cmp_eq_u32 s75, 0
    s_cbranch_scc1 Lqd_22
    s_waitcnt vmcnt(0)
Lqd_22:
    v_mfma_f32_16x16x32_bf16 v[48:51], a[32:35], v[32:35], v[48:51]
    v_mov_b32_dpp v16, v32 row_shr:4 row_mask:0xf bank_mask:0xf bound_ctrl:0
    v_mov_b32_dpp v17, v33 row_shr:4 row_mask:0xf bank_mask:0xf bound_ctrl:0
    v_mfma_f32_16x16x32_bf16 v[48:51], a[36:39], v[36:39], v[48:51]
    v_mov_b32_dpp v18, v34 row_shr:4 row_mask:0xf bank_mask:0xf bound_ctrl:0
    v_mfma_f32_16x16x32_bf16 v[48:51], a[40:43], v[40:43], v[48:51]
    v_mov_b32_dpp v19, v35 row_shr:4 row_mask:0xf bank_mask:0xf bound_ctrl:0
    v_mfma_f32_16x16x32_bf16 v[48:51], a[44:47], v[44:47], v[48:51]
    v_mov_b32_dpp v20, v36 row_shr:4 row_mask:0xf bank_mask:0xf bound_ctrl:0
    v_mfma_f32_16x16x32_bf16 v[52:55], a[48:51], v[32:35], v[52:55]
    v_mov_b32_dpp v21, v37 row_shr:4 row_mask:0xf bank_mask:0xf bound_ctrl:0
    v_mfma_f32_16x16x32_bf16 v[52:55], a[52:55], v[36:39], v[52:55]
    v_mov_b32_dpp v22, v38 row_shr:4 row_mask:0xf bank_mask:0xf bound_ctrl:0
    v_mfma_f32_16x16x32_bf16 v[52:55], a[56:59], v[40:43], v[52:55]
    v_mov_b32_dpp v23, v39 row_shr:4 row_mask:0xf bank_mask:0xf bound_ctrl:0
    v_mfma_f32_16x16x32_bf16 v[52:55], a[60:63], v[44:47], v[52:55]
    v_mov_b32_dpp v24, v40 row_shr:4 row_mask:0xf bank_mask:0xf bound_ctrl:0
    v_mov_b32_dpp v25, v41 row_shr:4 row_mask:0xf bank_mask:0xf bound_ctrl:0
    v_mfma_f32_16x16x32_bf16 v[56:59], a[160:163], v[32:35], v[56:59]
    v_mov_b32_dpp v26, v42 row_shr:4 row_mask:0xf bank_mask:0xf bound_ctrl:0
    v_mfma_f32_16x16x32_bf16 v[56:59], a[164:167], v[36:39], v[56:59]
    v_mov_b32_dpp v27, v43 row_shr:4 row_mask:0xf bank_mask:0xf bound_ctrl:0
    v_mfma_f32_16x16x32_bf16 v[56:59], a[168:171], v[40:43], v[56:59]
    v_mov_b32_dpp v28, v44 row_shr:4 row_mask:0xf bank_mask:0xf bound_ctrl:0
    v_mfma_f32_16x16x32_bf16 v[56:59], a[172:175], v[44:47], v[56:59]
    v_mov_b32_dpp v29, v45 row_shr:4 row_mask:0xf bank_mask:0xf bound_ctrl:0
    v_mfma_f32_16x16x32_bf16 v[60:63], a[176:179], v[32:35], v[60:63]
    v_mov_b32_dpp v30, v46 row_shr:4 row_mask:0xf bank_mask:0xf bound_ctrl:0
    v_mfma_f32_16x16x32_bf16 v[60:63], a[180:183], v[36:39], v[60:63]
    v_mov_b32_dpp v31, v47 row_shr:4 row_mask:0xf bank_mask:0xf bound_ctrl:0
    v_mfma_f32_16x16x32_bf16 v[60:63], a[184:187], v[40:43], v[60:63]
    v_mfma_f32_16x16x32_bf16 v[60:63], a[188:191], v[44:47], v[60:63]
    v_mfma_f32_16x16x32_bf16 v[48:51], a[64:67], v[16:19], v[48:51]
    v_mov_b32_dpp v32, v16 row_shr:4 row_mask:0xf bank_mask:0xf bound_ctrl:0
    v_mov_b32_dpp v33, v17 row_shr:4 row_mask:0xf bank_mask:0xf bound_ctrl:0
    v_mfma_f32_16x16x32_bf16 v[48:51], a[68:71], v[20:23], v[48:51]
    v_mov_b32_dpp v34, v18 row_shr:4 row_mask:0xf bank_mask:0xf bound_ctrl:0
    v_mfma_f32_16x16x32_bf16 v[48:51], a[72:75], v[24:27], v[48:51]
    v_mov_b32_dpp v35, v19 row_shr:4 row_mask:0xf bank_mask:0xf bound_ctrl:0
    v_mfma_f32_16x16x32_bf16 v[48:51], a[76:79], v[28:31], v[48:51]
    v_mov_b32_dpp v36, v20 row_shr:4 row_mask:0xf bank_mask:0xf bound_ctrl:0
    v_mfma_f32_16x16x32_bf16 v[52:55], a[80:83], v[16:19], v[52:55]
    v_mov_b32_dpp v37, v21 row_shr:4 row_mask:0xf bank_mask:0xf bound_ctrl:0
    v_mfma_f32_16x16x32_bf16 v[52:55], a[84:87], v[20:23], v[52:55]
    v_mov_b32_dpp v38, v22 row_shr:4 row_mask:0xf bank_mask:0xf bound_ctrl:0
    v_mfma_f32_16x16x32_bf16 v[52:55], a[88:91], v[24:27], v[52:55]
    v_mov_b32_dpp v39, v23 row_shr:4 row_mask:0xf bank_mask:0xf bound_ctrl:0
    v_mfma_f32_16x16x32_bf16 v[52:55], a[92:95], v[28:31], v[52:55]
    v_mov_b32_dpp v40, v24 row_shr:4 row_mask:0xf bank_mask:0xf bound_ctrl:0
    v_mov_b32_dpp v41, v25 row_shr:4 row_mask:0xf bank_mask:0xf bound_ctrl:0
    v_mfma_f32_16x16x32_bf16 v[56:59], a[192:195], v[16:19], v[56:59]
    v_mov_b32_dpp v42, v26 row_shr:4 row_mask:0xf bank_mask:0xf bound_ctrl:0
    v_mfma_f32_16x16x32_bf16 v[56:59], a[196:199], v[20:23], v[56:59]
    v_mov_b32_dpp v43, v27 row_shr:4 row_mask:0xf bank_mask:0xf bound_ctrl:0
    v_mfma_f32_16x16x32_bf16 v[56:59], a[200:203], v[24:27], v[56:59]
    v_mov_b32_dpp v44, v28 row_shr:4 row_mask:0xf bank_mask:0xf bound_ctrl:0
    v_mfma_f32_16x16x32_bf16 v[56:59], a[204:207], v[28:31], v[56:59]
    v_mov_b32_dpp v45, v29 row_shr:4 row_mask:0xf bank_mask:0xf bound_ctrl:0
    v_mfma_f32_16x16x32_bf16 v[60:63], a[208:211], v[16:19], v[60:63]
    v_mov_b32_dpp v46, v30 row_shr:4 row_mask:0xf bank_mask:0xf bound_ctrl:0
    v_mfma_f32_16x16x32_bf16 v[60:63], a[212:215], v[20:23], v[60:63]
    v_mov_b32_dpp v47, v31 row_shr:4 row_mask:0xf bank_mask:0xf bound_ctrl:0
    v_mfma_f32_16x16x32_bf16 v[60:63], a[216:219], v[24:27], v[60:63]
    v_mfma_f32_16x16x32_bf16 v[60:63], a[220:223], v[28:31], v[60:63]
    v_mfma_f32_16x16x32_bf16 v[48:51], a[96:99], v[32:35], v[48:51]
    v_lshlrev_b32 v12, 2, v0
    s_cmp_eq_u32 s36, 0
    v_mfma_f32_16x16x32_bf16 v[48:51], a[100:103], v[36:39], v[48:51]
    v_mfma_f32_16x16x32_bf16 v[48:51], a[104:107], v[40:43], v[48:51]
    v_mfma_f32_16x16x32_bf16 v[48:51], a[108:111], v[44:47], v[48:51]
    v_mfma_f32_16x16x32_bf16 v[52:55], a[112:115], v[32:35], v[52:55]
    s_nop 0
    v_mfma_f32_16x16x32_bf16 v[52:55], a[116:119], v[36:39], v[52:55]
    s_nop 0
    v_mfma_f32_16x16x32_bf16 v[52:55], a[120:123], v[40:43], v[52:55]
    s_nop 0
    v_mfma_f32_16x16x32_bf16 v[52:55], a[124:127], v[44:47], v[52:55]
    ds_read_b64_tr_b16 v[80:81], v3 offset:0
    ds_read_b64_tr_b16 v[82:83], v3 offset:12288
    v_mfma_f32_16x16x32_bf16 v[56:59], a[224:227], v[32:35], v[56:59]
    v_max3_f32 v10, v48, v49, v50
    v_mfma_f32_16x16x32_bf16 v[56:59], a[228:231], v[36:39], v[56:59]
    ds_read_b64_tr_b16 v[84:85], v4 offset:0
    ds_read_b64_tr_b16 v[86:87], v4 offset:12288
    v_mfma_f32_16x16x32_bf16 v[56:59], a[232:235], v[40:43], v[56:59]
    ds_read_b64_tr_b16 v[88:89], v5 offset:0
    ds_read_b64_tr_b16 v[90:91], v5 offset:12288
    v_mfma_f32_16x16x32_bf16 v[56:59], a[236:239], v[44:47], v[56:59]
    ds_read_b64_tr_b16 v[92:93], v6 offset:0
    ds_read_b64_tr_b16 v[94:95], v6 offset:12288
    v_mfma_f32_16x16x32_bf16 v[60:63], a[240:243], v[32:35], v[60:63]
    v_max3_f32 v10, v10, v51, v52
    v_max3_f32 v10, v10, v53, v54
    v_mfma_f32_16x16x32_bf16 v[60:63], a[244:247], v[36:39], v[60:63]
    s_nop 0
    v_mfma_f32_16x16x32_bf16 v[60:63], a[248:251], v[40:43], v[60:63]
    v_mfma_f32_16x16x32_bf16 v[60:63], a[252:255], v[44:47], v[60:63]
    s_nop 1
    v_max3_f32 v10, v10, v55, v56
    v_max3_f32 v10, v10, v57, v58
    v_max_f32 v10, v10, v59
    s_nop 2
    v_max3_f32 v11, v60, v61, v62
    v_max3_f32 v10, v10, v11, v63
    s_nop 1
    v_max_f32_dpp v10, v10, v10 row_ror:4 row_mask:0xf bank_mask:0xf
    s_nop 1
    v_max_f32_dpp v10, v10, v10 row_ror:8 row_mask:0xf bank_mask:0xf
    v_mov_b32 v11, v10
    s_nop 1
    v_permlane16_swap_b32 v10, v11
    v_max_f32 v10, v10, v11
    v_mov_b32 v11, v10
    s_nop 1
    v_permlane32_swap_b32 v10, v11
    v_max_f32 v10, v10, v11
    s_mov_b64 exec, 0xf
    s_cbranch_scc1 Ls_23
    buffer_store_dword v10, v12, s[16:19], s10 offen
Ls_24:
    s_mov_b64 exec, -1
    v_mul_f32 v14, s45, v10
    v_pk_fma_f32 v[48:49], v[48:49], s[44:45], v[14:15] op_sel:[0,1,0] op_sel_hi:[1,1,0] neg_lo:[0,0,1] neg_hi:[0,0,1]
    v_pk_fma_f32 v[50:51], v[50:51], s[44:45], v[14:15] op_sel:[0,1,0] op_sel_hi:[1,1,0] neg_lo:[0,0,1] neg_hi:[0,0,1]
    v_pk_fma_f32 v[52:53], v[52:53], s[44:45], v[14:15] op_sel:[0,1,0] op_sel_hi:[1,1,0] neg_lo:[0,0,1] neg_hi:[0,0,1]
    v_pk_fma_f32 v[54:55], v[54:55], s[44:45], v[14:15] op_sel:[0,1,0] op_sel_hi:[1,1,0] neg_lo:[0,0,1] neg_hi:[0,0,1]
    v_pk_fma_f32 v[56:57], v[56:57], s[44:45], v[14:15] op_sel:[0,1,0] op_sel_hi:[1,1,0] neg_lo:[0,0,1] neg_hi:[0,0,1]
    v_pk_fma_f32 v[58:59], v[58:59], s[44:45], v[14:15] op_sel:[0,1,0] op_sel_hi:[1,1,0] neg_lo:[0,0,1] neg_hi:[0,0,1]
    v_pk_fma_f32 v[60:61], v[60:61], s[44:45], v[14:15] op_sel:[0,1,0] op_sel_hi:[1,1,0] neg_lo:[0,0,1] neg_hi:[0,0,1]
    v_pk_fma_f32 v[62:63], v[62:63], s[44:45], v[14:15] op_sel:[0,1,0] op_sel_hi:[1,1,0] neg_lo:[0,0,1] neg_hi:[0,0,1]
    v_exp_f32 v48, v48
    v_exp_f32 v49, v49
    v_exp_f32 v50, v50
    v_exp_f32 v51, v51
    v_cvt_pk_bf16_f32 v64, v48, v49
    v_exp_f32 v52, v52
    v_exp_f32 v53, v53
    v_cvt_pk_bf16_f32 v65, v50, v51
    v_exp_f32 v54, v54
    v_exp_f32 v55, v55
    v_cvt_pk_bf16_f32 v66, v52, v53
    v_cvt_pk_bf16_f32 v67, v54, v55
    s_cmp_lg_u32 s37, 0
    s_cbranch_scc1 Lp2_25
    s_lshl_b32 s33, s5, 2
    s_add_u32 s33, s33, s3
    v_lshlrev_b32 v7, 7, v0
    s_mul_i32 s47, s33, 768
    s_add_u32 s47, s47, s35
    s_add_u32 s47, s47, 16384
    s_mov_b64 exec, 63
    buffer_load_dword v11, v7, s[16:19], s47 offen sc1
    s_mov_b64 exec, -1
    v_lshlrev_b32 v7, 2, v0
    buffer_load_dword v13, v7, s[24:27], 0 offen sc1
    s_xor_b32 s33, s32, 811008
    s_add_u32 m0, s34, 0
    s_nop 0
    buffer_load_dwordx4 v2, s[12:15], s33 offen offset:0 nt lds
    s_add_u32 m0, s34, 896
    s_nop 0
    buffer_load_dwordx4 v2, s[12:15], s33 offen offset:128 nt lds
    s_add_u32 m0, s34, 0
    s_nop 0
    buffer_load_dwordx4 v2, s[12:15], s33 offen offset:2048 nt lds
    s_add_u32 m0, s34, 896
    s_nop 0
    buffer_load_dwordx4 v2, s[12:15], s33 offen offset:2176 nt lds
    s_waitcnt vmcnt(15)
    ds_read_b64_tr_b16 v[194:195], v3 offset:4096
    ds_read_b64_tr_b16 v[198:199], v4 offset:4096
    ds_read_b64_tr_b16 v[202:203], v5 offset:4096
    ds_read_b64_tr_b16 v[206:207], v6 offset:4096
    ds_read_b64_tr_b16 v[210:211], v3 offset:5120
    ds_read_b64_tr_b16 v[214:215], v4 offset:5120
    ds_read_b64_tr_b16 v[218:219], v5 offset:5120
    ds_read_b64_tr_b16 v[222:223], v6 offset:5120
    s_xor_b32 s33, s32, 946176
    s_add_u32 m0, s34, 12288
    s_nop 0
    buffer_load_dwordx4 v2, s[12:15], s33 offen offset:0 nt lds
    s_add_u32 m0, s34, 13184
    s_nop 0
    buffer_load_dwordx4 v2, s[12:15], s33 offen offset:128 nt lds
    s_add_u32 m0, s34, 12288
    s_nop 0
    buffer_load_dwordx4 v2, s[12:15], s33 offen offset:2048 nt lds
    s_add_u32 m0, s34, 13184
    s_nop 0
    buffer_load_dwordx4 v2, s[12:15], s33 offen offset:2176 nt lds
    s_waitcnt vmcnt(15)
    ds_read_b64_tr_b16 v[224:225], v3 offset:20480
    ds_read_b64_tr_b16 v[228:229], v4 offset:20480
    ds_read_b64_tr_b16 v[232:233], v5 offset:20480
    ds_read_b64_tr_b16 v[236:237], v6 offset:20480
    ds_read_b64_tr_b16 v[240:241], v3 offset:21504
    ds_read_b64_tr_b16 v[244:245], v4 offset:21504
    ds_read_b64_tr_b16 v[248:249], v5 offset:21504
    ds_read_b64_tr_b16 v[252:253], v6 offset:21504
    s_xor_b32 s33, s32, 1323008
    s_add_u32 m0, s34, 8192
    s_nop 0
    buffer_load_dwordx4 v2, s[12:15], s33 offen offset:0 nt lds
    s_add_u32 m0, s34, 9088
    s_nop 0
    buffer_load_dwordx4 v2, s[12:15], s33 offen offset:128 nt lds
    s_add_u32 m0, s34, 8192
    s_nop 0
    buffer_load_dwordx4 v2, s[12:15], s33 offen offset:2048 nt lds
    s_add_u32 m0, s34, 9088
    s_nop 0
    buffer_load_dwordx4 v2, s[12:15], s33 offen offset:2176 nt lds
    s_waitcnt vmcnt(15)
    ds_read_b64_tr_b16 v[226:227], v3 offset:16384
    ds_read_b64_tr_b16 v[230:231], v4 offset:16384
    ds_read_b64_tr_b16 v[234:235], v5 offset:16384
    ds_read_b64_tr_b16 v[238:239], v6 offset:16384
    ds_read_b64_tr_b16 v[242:243], v3 offset:17408
    ds_read_b64_tr_b16 v[246:247], v4 offset:17408
    ds_read_b64_tr_b16 v[250:251], v5 offset:17408
    ds_read_b64_tr_b16 v[254:255], v6 offset:17408
    s_waitcnt lgkmcnt(0)
    s_xor_b32 s33, s32, 1449984
    s_add_u32 m0, s34, 4096
    s_nop 0
    buffer_load_dwordx4 v2, s[12:15], s33 offen offset:0 nt lds
    s_add_u32 m0, s34, 4992
    s_nop 0
    buffer_load_dwordx4 v2, s[12:15], s33 offen offset:128 nt lds
    s_add_u32 m0, s34, 4096
    s_nop 0
    buffer_load_dwordx4 v2, s[12:15], s33 offen offset:2048 nt lds
    s_add_u32 m0, s34, 4992
    s_nop 0
    buffer_load_dwordx4 v2, s[12:15], s33 offen offset:2176 nt lds
    s_xor_b32 s33, s32, 1863680
    s_add_u32 m0, s34, 20480
    s_nop 0
    buffer_load_dwordx4 v2, s[12:15], s33 offen offset:0 nt lds
    s_add_u32 m0, s34, 21376
    s_nop 0
    buffer_load_dwordx4 v2, s[12:15], s33 offen offset:128 nt lds
    s_add_u32 m0, s34, 20480
    s_nop 0
    buffer_load_dwordx4 v2, s[12:15], s33 offen offset:2048 nt lds
    s_add_u32 m0, s34, 21376
    s_nop 0
    buffer_load_dwordx4 v2, s[12:15], s33 offen offset:2176 nt lds
    s_xor_b32 s33, s32, 1990656
    s_add_u32 m0, s34, 16384
    s_nop 0
    buffer_load_dwordx4 v2, s[12:15], s33 offen offset:0 nt lds
    s_add_u32 m0, s34, 17280
    s_nop 0
    buffer_load_dwordx4 v2, s[12:15], s33 offen offset:128 nt lds
    s_add_u32 m0, s34, 16384
    s_nop 0
    buffer_load_dwordx4 v2, s[12:15], s33 offen offset:2048 nt lds
    s_add_u32 m0, s34, 17280
    s_nop 0
    buffer_load_dwordx4 v2, s[12:15], s33 offen offset:2176 nt lds
    s_waitcnt lgkmcnt(0)
    s_waitcnt vmcnt(16)
    ds_read_b64_tr_b16 v[80:81], v3 offset:0
    ds_read_b64_tr_b16 v[82:83], v3 offset:12288
    ds_read_b64_tr_b16 v[84:85], v4 offset:0
    ds_read_b64_tr_b16 v[86:87], v4 offset:12288
    ds_read_b64_tr_b16 v[88:89], v5 offset:0
    ds_read_b64_tr_b16 v[90:91], v5 offset:12288
    ds_read_b64_tr_b16 v[92:93], v6 offset:0
    ds_read_b64_tr_b16 v[94:95], v6 offset:12288
Lp2_25:
L_PVB:
    v_mfma_f32_16x16x32_bf16 v[16:19], v[96:99], v[64:67], 0
    v_mov_b32_dpp v68, v64 row_shl:4 row_mask:0xf bank_mask:0xf bound_ctrl:0
    v_mov_b32_dpp v69, v65 row_shl:4 row_mask:0xf bank_mask:0xf bound_ctrl:0
    v_mov_b32_dpp v70, v66 row_shl:4 row_mask:0xf bank_mask:0xf bound_ctrl:0
    v_mfma_f32_16x16x32_bf16 v[20:23], v[100:103], v[64:67], 0
    v_mov_b32_dpp v71, v67 row_shl:4 row_mask:0xf bank_mask:0xf bound_ctrl:0
    v_add_f32 v14, v48, v49
    v_add_f32 v14, v14, v50
    v_mfma_f32_16x16x32_bf16 v[24:27], v[104:107], v[64:67], 0
    v_add_f32 v14, v14, v51
    v_add_f32 v14, v14, v52
    v_add_f32 v14, v14, v53
    v_mfma_f32_16x16x32_bf16 v[28:31], v[108:111], v[64:67], 0
    v_add_f32 v14, v14, v54
    v_add_f32 v14, v14, v55
    v_mov_b32_dpp v72, v64 row_shl:8 row_mask:0xf bank_mask:0xf bound_ctrl:0
    v_mfma_f32_16x16x32_bf16 v[32:35], v[112:115], v[64:67], 0
    v_mov_b32_dpp v73, v65 row_shl:8 row_mask:0xf bank_mask:0xf bound_ctrl:0
    v_mov_b32_dpp v74, v66 row_shl:8 row_mask:0xf bank_mask:0xf bound_ctrl:0
    v_mov_b32_dpp v75, v67 row_shl:8 row_mask:0xf bank_mask:0xf bound_ctrl:0
    v_mfma_f32_16x16x32_bf16 v[36:39], v[116:119], v[64:67], 0
    v_mov_b32_dpp v76, v64 row_shl:12 row_mask:0xf bank_mask:0xf bound_ctrl:0
    v_mov_b32_dpp v77, v65 row_shl:12 row_mask:0xf bank_mask:0xf bound_ctrl:0
    v_mov_b32_dpp v78, v66 row_shl:12 row_mask:0xf bank_mask:0xf bound_ctrl:0
    v_mfma_f32_16x16x32_bf16 v[40:43], v[120:123], v[64:67], 0
    v_mov_b32_dpp v79, v67 row_shl:12 row_mask:0xf bank_mask:0xf bound_ctrl:0
    v_exp_f32 v56, v56
    v_mfma_f32_16x16x32_bf16 v[44:47], v[124:127], v[64:67], 0
    v_exp_f32 v57, v57
    v_mfma_f32_16x16x32_bf16 v[16:19], v[128:131], v[68:71], v[16:19]
    v_exp_f32 v58, v58
    v_mfma_f32_16x16x32_bf16 v[20:23], v[132:135], v[68:71], v[20:23]
    v_exp_f32 v59, v59
    v_mfma_f32_16x16x32_bf16 v[24:27], v[136:139], v[68:71], v[24:27]
    v_exp_f32 v60, v60
    v_mfma_f32_16x16x32_bf16 v[28:31], v[140:143], v[68:71], v[28:31]
    v_exp_f32 v61, v61
    v_mfma_f32_16x16x32_bf16 v[32:35], v[144:147], v[68:71], v[32:35]
    v_exp_f32 v62, v62
    v_mfma_f32_16x16x32_bf16 v[36:39], v[148:151], v[68:71], v[36:39]
    v_exp_f32 v63, v63
    v_mfma_f32_16x16x32_bf16 v[40:43], v[152:155], v[68:71], v[40:43]
    ds_read_b64_tr_b16 v[48:49], v3 offset:1024
    ds_read_b64_tr_b16 v[50:51], v3 offset:13312
    v_mfma_f32_16x16x32_bf16 v[44:47], v[156:159], v[68:71], v[44:47]
    ds_read_b64_tr_b16 v[52:53], v4 offset:1024
    ds_read_b64_tr_b16 v[54:55], v4 offset:13312
    s_waitcnt lgkmcnt(8)
    v_mfma_f32_16x16x32_bf16 v[16:19], v[80:83], v[76:79], v[16:19]
    ds_read_b64_tr_b16 v[80:81], v5 offset:1024
    ds_read_b64_tr_b16 v[82:83], v5 offset:13312
    v_mfma_f32_16x16x32_bf16 v[16:19], v[160:163], v[72:75], v[16:19]
    v_cvt_pk_bf16_f32 v64, v56, v57
    v_cvt_pk_bf16_f32 v65, v58, v59
    v_mfma_f32_16x16x32_bf16 v[20:23], v[84:87], v[76:79], v[20:23]
    ds_read_b64_tr_b16 v[84:85], v6 offset:1024
    ds_read_b64_tr_b16 v[86:87], v6 offset:13312
    v_mfma_f32_16x16x32_bf16 v[20:23], v[164:167], v[72:75], v[20:23]
    v_cvt_pk_bf16_f32 v66, v60, v61
    v_add_f32 v14, v14, v56
    s_waitcnt lgkmcnt(8)
    v_mfma_f32_16x16x32_bf16 v[24:27], v[88:91], v[76:79], v[24:27]
    s_waitcnt vmcnt(8)
    ds_read_b64_tr_b16 v[88:89], v3 offset:8192
    ds_read_b64_tr_b16 v[90:91], v3 offset:4096
    v_mfma_f32_16x16x32_bf16 v[24:27], v[168:171], v[72:75], v[24:27]
    v_cvt_pk_bf16_f32 v67, v62, v63
    v_mov_b32_dpp v68, v64 row_shl:4 row_mask:0xf bank_mask:0xf bound_ctrl:0
    v_mfma_f32_16x16x32_bf16 v[28:31], v[92:95], v[76:79], v[28:31]
    ds_read_b64_tr_b16 v[92:93], v4 offset:8192
    ds_read_b64_tr_b16 v[94:95], v4 offset:4096
    v_mfma_f32_16x16x32_bf16 v[28:31], v[172:175], v[72:75], v[28:31]
    v_mov_b32_dpp v69, v65 row_shl:4 row_mask:0xf bank_mask:0xf bound_ctrl:0
    v_mov_b32_dpp v70, v66 row_shl:4 row_mask:0xf bank_mask:0xf bound_ctrl:0
    s_waitcnt lgkmcnt(8)
    v_mfma_f32_16x16x32_bf16 v[32:35], v[48:51], v[76:79], v[32:35]
    ds_read_b64_tr_b16 v[48:49], v5 offset:8192
    ds_read_b64_tr_b16 v[50:51], v5 offset:4096
    v_mfma_f32_16x16x32_bf16 v[32:35], v[176:179], v[72:75], v[32:35]
    v_add_f32 v14, v14, v57
    v_mov_b32_dpp v71, v67 row_shl:4 row_mask:0xf bank_mask:0xf bound_ctrl:0
    buffer_load_dword v1, v12, s[16:19], s9 offen sc1
    buffer_load_dword v2, v12, s[16:19], s9 offen offset:256 sc1
    v_mfma_f32_16x16x32_bf16 v[36:39], v[52:55], v[76:79], v[36:39]
    ds_read_b64_tr_b16 v[52:53], v6 offset:8192
    ds_read_b64_tr_b16 v[54:55], v6 offset:4096
    v_mfma_f32_16x16x32_bf16 v[36:39], v[180:183], v[72:75], v[36:39]
    s_cmp_lg_u32 s37, 0
    s_cbranch_scc1 Ljp_26
    v_bfe_u32 v7, v0, 3, 2
    v_lshlrev_b32 v7, 3, v7
    v_lshrrev_b32 v11, 5, v0
    v_lshl_add_u32 v7, v11, 2, v7
    v_bfe_u32 v11, v0, 1, 2
    v_add_u32 v7, v7, v11
    v_lshlrev_b32 v7, 10, v7
    v_and_b32 v11, 1, v0
    v_lshl_add_u32 v7, v11, 4, v7
    s_mov_b32 s52, s72
    s_and_b32 s53, s73, 0xffff
    s_mov_b32 s54, 4194304
    s_mov_b32 s55, 0x20000
    s_lshl_b32 s33, s4, 19
    s_lshl_b32 s46, s3, 17
    s_add_u32 s33, s33, s46
    s_lshr_b32 s46, s3, 1
    s_lshl_b32 s46, s46, 15
    s_add_u32 s47, s46, 24576
    s_and_b32 s46, s3, 1
    s_lshl_b32 s46, s46, 12
    s_add_u32 s47, s47, s46
    s_lshl_b32 s46, s5, 5
    s_add_u32 s33, s33, s46
    s_add_u32 m0, s47, 0
    s_nop 0
    buffer_load_dwordx4 v7, s[52:55], s33 offen  lds
    s_add_u32 m0, s47, 1024
    s_add_u32 s33, s33, 32768
    buffer_load_dwordx4 v7, s[52:55], s33 offen  lds
    s_add_u32 m0, s47, 2048
    s_add_u32 s33, s33, 32768
    buffer_load_dwordx4 v7, s[52:55], s33 offen  lds
    s_add_u32 m0, s47, 3072
    s_add_u32 s33, s33, 32768
    buffer_load_dwordx4 v7, s[52:55], s33 offen  lds
    s_mov_b32 s52, s80
    s_and_b32 s53, s81, 0xffff
    s_mov_b32 s54, 1835008
    s_mov_b32 s55, 0x20000
    s_lshl_b32 s46, s3, 1
    s_min_u32 s46, s46, 5
    s_lshl_b32 s47, s46, 10
    s_add_u32 s47, s47, 147456
    s_lshl_b32 s46, s46, 15
    s_mul_i32 s33, s4, 229376
    s_add_u32 s33, s33, s46
    s_lshl_b32 s46, s5, 5
    s_add_u32 s33, s33, s46
    s_add_u32 m0, s47, 0
    s_nop 0
    buffer_load_dwordx4 v7, s[52:55], s33 offen  lds
    s_add_u32 m0, s47, 1024
    s_add_u32 s33, s33, 32768
    buffer_load_dwordx4 v7, s[52:55], s33 offen  lds
Ljp_26:
    s_waitcnt lgkmcnt(8)
    v_mfma_f32_16x16x32_bf16 v[40:43], v[80:83], v[76:79], v[40:43]
    ds_read_b64_tr_b16 v[80:81], v3 offset:9216
    ds_read_b64_tr_b16 v[82:83], v3 offset:5120
    v_mfma_f32_16x16x32_bf16 v[40:43], v[184:187], v[72:75], v[40:43]
    v_mfma_f32_16x16x32_bf16 v[44:47], v[84:87], v[76:79], v[44:47]
    ds_read_b64_tr_b16 v[84:85], v4 offset:9216
    ds_read_b64_tr_b16 v[86:87], v4 offset:5120
    v_mfma_f32_16x16x32_bf16 v[44:47], v[188:191], v[72:75], v[44:47]
    s_waitcnt lgkmcnt(8)
    v_mfma_f32_16x16x32_bf16 v[16:19], v[88:91], v[68:71], v[16:19]
    ds_read_b64_tr_b16 v[88:89], v5 offset:9216
    ds_read_b64_tr_b16 v[90:91], v5 offset:5120
    v_mfma_f32_16x16x32_bf16 v[16:19], v[192:195], v[64:67], v[16:19]
    v_mov_b32_dpp v72, v64 row_shl:8 row_mask:0xf bank_mask:0xf bound_ctrl:0
    v_mov_b32_dpp v73, v65 row_shl:8 row_mask:0xf bank_mask:0xf bound_ctrl:0
    v_mfma_f32_16x16x32_bf16 v[20:23], v[92:95], v[68:71], v[20:23]
    ds_read_b64_tr_b16 v[92:93], v6 offset:9216
    ds_read_b64_tr_b16 v[94:95], v6 offset:5120
    v_mfma_f32_16x16x32_bf16 v[20:23], v[196:199], v[64:67], v[20:23]
    v_mov_b32_dpp v74, v66 row_shl:8 row_mask:0xf bank_mask:0xf bound_ctrl:0
    v_mov_b32_dpp v75, v67 row_shl:8 row_mask:0xf bank_mask:0xf bound_ctrl:0
    s_waitcnt lgkmcnt(8)
    v_mfma_f32_16x16x32_bf16 v[24:27], v[48:51], v[68:71], v[24:27]
    v_mov_b32_dpp v76, v64 row_shl:12 row_mask:0xf bank_mask:0xf bound_ctrl:0
    v_mov_b32_dpp v77, v65 row_shl:12 row_mask:0xf bank_mask:0xf bound_ctrl:0
    v_mfma_f32_16x16x32_bf16 v[24:27], v[200:203], v[64:67], v[24:27]
    v_mov_b32_dpp v78, v66 row_shl:12 row_mask:0xf bank_mask:0xf bound_ctrl:0
    v_mov_b32_dpp v79, v67 row_shl:12 row_mask:0xf bank_mask:0xf bound_ctrl:0
    v_mfma_f32_16x16x32_bf16 v[28:31], v[52:55], v[68:71], v[28:31]
    v_add_f32 v14, v14, v58
    v_add_f32 v14, v14, v59
    v_mfma_f32_16x16x32_bf16 v[28:31], v[204:207], v[64:67], v[28:31]
    v_add_f32 v14, v14, v60
    v_add_f32 v14, v14, v61
    s_waitcnt lgkmcnt(4)
    v_mfma_f32_16x16x32_bf16 v[32:35], v[80:83], v[68:71], v[32:35]
    v_add_f32 v14, v14, v62
    v_add_f32 v14, v14, v63
    v_mfma_f32_16x16x32_bf16 v[32:35], v[208:211], v[64:67], v[32:35]
    v_lshl_add_u32 v58, v0, 4, s61
    v_lshl_add_u32 v59, v12, 2, s62
    v_mfma_f32_16x16x32_bf16 v[36:39], v[84:87], v[68:71], v[36:39]
    v_mfma_f32_16x16x32_bf16 v[36:39], v[212:215], v[64:67], v[36:39]
    v_mov_b32 v57, s41
    s_waitcnt lgkmcnt(0)
    v_mfma_f32_16x16x32_bf16 v[40:43], v[88:91], v[68:71], v[40:43]
    s_waitcnt vmcnt(6)
    s_cmp_eq_u32 s37, 0
    s_cbranch_scc1 Lv7_27
    s_waitcnt vmcnt(0)
Lv7_27:
    ds_read_b64_tr_b16 v[48:49], v3 offset:20480
    ds_read_b64_tr_b16 v[50:51], v3 offset:16384
    v_mfma_f32_16x16x32_bf16 v[40:43], v[216:219], v[64:67], v[40:43]
    ds_read_b64_tr_b16 v[52:53], v4 offset:20480
    ds_read_b64_tr_b16 v[54:55], v4 offset:16384
    v_mfma_f32_16x16x32_bf16 v[44:47], v[92:95], v[68:71], v[44:47]
    ds_read_b64_tr_b16 v[80:81], v5 offset:20480
    ds_read_b64_tr_b16 v[82:83], v5 offset:16384
    v_mfma_f32_16x16x32_bf16 v[44:47], v[220:223], v[64:67], v[44:47]
    ds_read_b64_tr_b16 v[84:85], v6 offset:20480
    ds_read_b64_tr_b16 v[86:87], v6 offset:16384
    v_mfma_f32_16x16x32_bf16 v[16:19], v[224:227], v[72:75], v[16:19]
    ds_read_b64_tr_b16 v[88:89], v3 offset:21504
    ds_read_b64_tr_b16 v[90:91], v3 offset:17408
    v_mfma_f32_16x16x32_bf16 v[20:23], v[228:231], v[72:75], v[20:23]
    ds_read_b64_tr_b16 v[92:93], v4 offset:21504
    ds_read_b64_tr_b16 v[94:95], v4 offset:17408
    v_mfma_f32_16x16x32_bf16 v[24:27], v[232:235], v[72:75], v[24:27]
    v_max_u32 v11, v1, v2
    v_max_f32 v1, v1, v2
    v_mfma_f32_16x16x32_bf16 v[28:31], v[236:239], v[72:75], v[28:31]
    v_cmp_eq_u32 s[56:57], -1, v11
    v_add_f32_dpp v14, v14, v14 row_ror:4 row_mask:0xf bank_mask:0xf
    s_waitcnt lgkmcnt(8)
    v_mfma_f32_16x16x32_bf16 v[16:19], v[48:51], v[76:79], v[16:19]
    ds_read_b64_tr_b16 v[48:49], v5 offset:21504
    ds_read_b64_tr_b16 v[50:51], v5 offset:17408
    v_mfma_f32_16x16x32_bf16 v[20:23], v[52:55], v[76:79], v[20:23]
    ds_read_b64_tr_b16 v[52:53], v6 offset:21504
    ds_read_b64_tr_b16 v[54:55], v6 offset:17408
    s_waitcnt lgkmcnt(8)
    v_mfma_f32_16x16x32_bf16 v[24:27], v[80:83], v[76:79], v[24:27]
    v_max_f32_dpp v1, v1, v1 row_ror:4 row_mask:0xf bank_mask:0xf
    v_add_f32_dpp v14, v14, v14 row_ror:8 row_mask:0xf bank_mask:0xf
    v_mfma_f32_16x16x32_bf16 v[28:31], v[84:87], v[76:79], v[28:31]
    s_nop 0
    v_max_f32_dpp v1, v1, v1 row_ror:8 row_mask:0xf bank_mask:0xf
    v_mfma_f32_16x16x32_bf16 v[32:35], v[240:243], v[72:75], v[32:35]
    v_mov_b32 v15, v14
    v_mov_b32 v2, v1
    v_mfma_f32_16x16x32_bf16 v[36:39], v[244:247], v[72:75], v[36:39]
    v_permlane16_swap_b32 v14, v15
    v_permlane16_swap_b32 v1, v2
    v_mfma_f32_16x16x32_bf16 v[40:43], v[248:251], v[72:75], v[40:43]
    v_add_f32 v14, v14, v15
    v_max_f32 v1, v1, v2
    v_mfma_f32_16x16x32_bf16 v[44:47], v[252:255], v[72:75], v[44:47]
    v_mov_b32_dpp v16, v20 row_shr:4 row_mask:0xf bank_mask:0x2
    v_mov_b32_dpp v17, v21 row_shr:4 row_mask:0xf bank_mask:0x2
    s_waitcnt lgkmcnt(4)
    v_mfma_f32_16x16x32_bf16 v[32:35], v[88:91], v[76:79], v[32:35]
    v_mov_b32_dpp v18, v22 row_shr:4 row_mask:0xf bank_mask:0x2
    v_mov_b32_dpp v19, v23 row_shr:4 row_mask:0xf bank_mask:0x2
    v_mfma_f32_16x16x32_bf16 v[36:39], v[92:95], v[76:79], v[36:39]
    v_mov_b32_dpp v16, v24 row_shr:8 row_mask:0xf bank_mask:0x4
    v_mov_b32_dpp v17, v25 row_shr:8 row_mask:0xf bank_mask:0x4
    s_waitcnt lgkmcnt(0)
    v_mfma_f32_16x16x32_bf16 v[40:43], v[48:51], v[76:79], v[40:43]
    v_mov_b32_dpp v18, v26 row_shr:8 row_mask:0xf bank_mask:0x4
    v_mov_b32_dpp v19, v27 row_shr:8 row_mask:0xf bank_mask:0x4
    v_mfma_f32_16x16x32_bf16 v[44:47], v[52:55], v[76:79], v[44:47]
    v_mov_b32_dpp v16, v28 row_shr:12 row_mask:0xf bank_mask:0x8
    v_mov_b32_dpp v17, v29 row_shr:12 row_mask:0xf bank_mask:0x8
    v_mov_b32_dpp v18, v30 row_shr:12 row_mask:0xf bank_mask:0x8
    v_mov_b32_dpp v19, v31 row_shr:12 row_mask:0xf bank_mask:0x8
    ds_write_b128 v58, v[16:19]
    s_cmp_lg_u64 s[56:57], 0
    s_cbranch_scc1 L_STRETRY
L_MRED_OK:
    v_mov_b32 v2, v1
    v_mov_b32 v15, v14
    v_mov_b32_dpp v32, v36 row_shr:4 row_mask:0xf bank_mask:0x2
    v_permlane32_swap_b32 v1, v2
    v_permlane32_swap_b32 v14, v15
    v_max_f32 v1, v1, v2
    v_add_f32 v14, v14, v15
    v_sub_f32 v1, v10, v1
    v_mul_f32 v1, s45, v1
    v_exp_f32 v1, v1
    v_mov_b32_dpp v33, v37 row_shr:4 row_mask:0xf bank_mask:0x2
    v_mov_b32_dpp v34, v38 row_shr:4 row_mask:0xf bank_mask:0x2
    v_mov_b32_dpp v35, v39 row_shr:4 row_mask:0xf bank_mask:0x2
    v_mov_b32_dpp v32, v40 row_shr:8 row_mask:0xf bank_mask:0x4
    v_mov_b32_dpp v33, v41 row_shr:8 row_mask:0xf bank_mask:0x4
    v_mov_b32_dpp v34, v42 row_shr:8 row_mask:0xf bank_mask:0x4
    v_mov_b32_dpp v35, v43 row_shr:8 row_mask:0xf bank_mask:0x4
    v_mov_b32_dpp v32, v44 row_shr:12 row_mask:0xf bank_mask:0x8
    v_mov_b32_dpp v33, v45 row_shr:12 row_mask:0xf bank_mask:0x8
    v_mov_b32_dpp v34, v46 row_shr:12 row_mask:0xf bank_mask:0x8
    v_mov_b32_dpp v35, v47 row_shr:12 row_mask:0xf bank_mask:0x8
    ds_write_b128 v58, v[32:35] offset:1024
    s_mov_b64 exec, 0xf
    v_mul_f32 v14, v1, v14
    ds_write2_b32 v59, v1, v14 offset0:0 offset1:16
    s_mov_b64 exec, -1
    v_lshlrev_b32 v10, 3, v0
    v_bfe_u32 v12, v0, 4, 2
    v_lshlrev_b32 v12, 11, v12
    v_bfe_u32 v15, v0, 0, 4
    v_lshl_add_u32 v12, v15, 4, v12
    s_cmp_eq_u32 s36, 0
    s_waitcnt lgkmcnt(0)
    s_barrier
    ds_read_b128 v[28:31], v57 offset:8256
    ds_read_b128 v[24:27], v57 offset:8192
    ds_read_b64 v[16:17], v9 offset:0
    ds_read_b64 v[18:19], v9 offset:2048
    ds_read_b64 v[20:21], v9 offset:4096
    ds_read_b64 v[22:23], v9 offset:6144
    s_waitcnt lgkmcnt(5)
    v_pk_add_f32 v[34:35], v[28:29], v[30:31]
    v_add_f32 v34, v34, v35
    s_waitcnt lgkmcnt(3)
    v_pk_mul_f32 v[32:33], v[16:17], v[24:25] op_sel_hi:[1,0]
    s_waitcnt lgkmcnt(2)
    v_pk_fma_f32 v[32:33], v[18:19], v[24:25], v[32:33] op_sel:[0,1,0] op_sel_hi:[1,1,1]
    s_waitcnt lgkmcnt(1)
    v_pk_fma_f32 v[32:33], v[20:21], v[26:27], v[32:33] op_sel_hi:[1,0,1]
    s_waitcnt lgkmcnt(0)
    v_pk_fma_f32 v[32:33], v[22:23], v[26:27], v[32:33] op_sel:[0,1,0] op_sel_hi:[1,1,1]
    s_cbranch_scc1 Lpa_28
    buffer_store_dwordx2 v[32:33], v10, s[16:19], s11 offen
    s_mov_b64 exec, 1
    buffer_store_dword v34, off, s[16:19], s60
Lpa_29:
    s_mov_b64 exec, -1
    s_cmp_eq_u32 s3, 1
    s_cbranch_scc1 L_W1
    s_cmp_eq_u32 s3, 2
    s_cbranch_scc1 L_W2
    s_cmp_eq_u32 s3, 3
    s_cbranch_scc1 L_W3
    s_add_u32 s48, s63, 8192
    buffer_load_dwordx4 v[52:55], off, s[16:19], s40 sc1
    buffer_load_dwordx4 v[56:59], off, s[16:19], s40 offset:16 sc1
    buffer_load_dwordx4 v[16:19], v12, s[16:19], s63 offen sc1
    buffer_load_dwordx4 v[20:23], v12, s[16:19], s48 offen sc1
    v_bfe_u32 v13, v0, 1, 2
    v_lshlrev_b32 v13, 8, v13
    v_bfe_u32 v15, v0, 3, 1
    v_lshl_add_u32 v13, v15, 6, v13
    v_bfe_u32 v15, v0, 0, 1
    v_lshl_add_u32 v13, v15, 3, v13
    v_bfe_u32 v15, v0, 5, 1
    v_lshl_add_u32 v13, v15, 2, v13
    s_bfe_u32 s33, s7, 131073
    s_lshl_b32 s33, s33, 10
    s_add_u32 s47, s35, s33
    s_bfe_u32 s33, s7, 65536
    s_lshl_b32 s33, s33, 7
    s_add_u32 s47, s47, s33
    s_add_u32 s47, s47, 81920
    s_lshl_b32 s33, s6, 4
    s_add_u32 s47, s47, s33
L_A1:
    buffer_load_dwordx4 v[52:55], off, s[16:19], s40 sc1
    buffer_load_dwordx4 v[56:59], off, s[16:19], s40 offset:16 sc1
    buffer_load_dwordx4 v[16:19], v12, s[16:19], s63 offen sc1
    buffer_load_dwordx4 v[20:23], v12, s[16:19], s48 offen sc1
    s_sub_u32 s43, s43, 1
    s_cbranch_scc1 Lgu_31
Lpk_30:
    s_waitcnt vmcnt(6)
    v_pk_add_f32 v[60:61], v[52:53], v[54:55]
    v_pk_add_f32 v[62:63], v[56:57], v[58:59]
    v_pk_add_f32 v[60:61], v[60:61], v[62:63]
    v_add_f32 v60, v60, v61
    v_rcp_f32 v60, v60
    s_waitcnt vmcnt(4)
    v_pk_add_f32 v[48:49], v[16:17], v[20:21]
    v_pk_add_f32 v[50:51], v[18:19], v[22:23]
    s_nop 1
    v_permlane32_swap_b32 v48, v50
    v_permlane32_swap_b32 v49, v51
    v_pk_add_f32 v[48:49], v[48:49], v[50:51]
    v_mov_b32 v50, v48
    v_mov_b32 v51, v49
    s_nop 0
    v_permlane16_swap_b32 v48, v50
    v_permlane16_swap_b32 v49, v51
    v_pk_add_f32 v[48:49], v[48:49], v[50:51]
    v_pk_mul_f32 v[48:49], v[48:49], v[60:61] op_sel_hi:[1,0]
    v_cmp_u_f32 vcc, v48, v49
    s_and_b64 vcc, vcc, s[0:1]
    s_cbranch_scc1 L_A1
    v_cvt_pk_bf16_f32 v48, v48, v49
    s_cmp_eq_u32 s36, 0
    s_cbranch_scc1 Ls_32
    buffer_store_dword v48, v13, s[16:19], s47 offen
Ls_33:
    s_barrier
    s_cmp_lg_u32 s37, 0
    s_cbranch_scc1 L_FIN
    s_waitcnt vmcnt(0)
    v_lshlrev_b32 v14, 3, v0
    v_add_u32 v14, 131072, v14
    v_mov_b32 v48, s44
    v_mov_b32 v49, s44
    v_mov_b32 v50, s44
    v_mov_b32 v51, s44
    ds_read_b64_tr_b16 v[64:65], v14 offset:8192
    ds_read_b64_tr_b16 v[66:67], v14 offset:8704
    ds_read_b64_tr_b16 v[68:69], v14 offset:9216
    ds_read_b64_tr_b16 v[70:71], v14 offset:9728
    ds_read_b64_tr_b16 v[72:73], v14 offset:10240
    ds_read_b64_tr_b16 v[74:75], v14 offset:10752
    ds_read_b64_tr_b16 v[76:77], v14 offset:11264
    ds_read_b64_tr_b16 v[78:79], v14 offset:11776
    ds_read_b64_tr_b16 v[80:81], v14 offset:12288
    ds_read_b64_tr_b16 v[82:83], v14 offset:12800
    ds_read_b64_tr_b16 v[84:85], v14 offset:13312
    ds_read_b64_tr_b16 v[86:87], v14 offset:13824
    s_waitcnt lgkmcnt(4)
    ds_read_b64_tr_b16 v[88:89], v14 offset:14336
    ds_read_b64_tr_b16 v[90:91], v14 offset:14848
    ds_read_b64_tr_b16 v[92:93], v14 offset:15360
    ds_read_b64_tr_b16 v[94:95], v14 offset:15872
    s_waitcnt lgkmcnt(0)
    v_mfma_f32_16x16x32_bf16 v[60:63], v[64:67], v[48:51], 0
    v_mfma_f32_16x16x32_bf16 v[60:63], v[68:71], v[48:51], v[60:63]
    v_mfma_f32_16x16x32_bf16 v[60:63], v[72:75], v[48:51], v[60:63]
    v_mfma_f32_16x16x32_bf16 v[60:63], v[76:79], v[48:51], v[60:63]
    v_mfma_f32_16x16x32_bf16 v[60:63], v[80:83], v[48:51], v[60:63]
    v_mfma_f32_16x16x32_bf16 v[60:63], v[84:87], v[48:51], v[60:63]
    v_mfma_f32_16x16x32_bf16 v[60:63], v[88:91], v[48:51], v[60:63]
    v_mfma_f32_16x16x32_bf16 v[60:63], v[92:95], v[48:51], v[60:63]
    ds_read_b64_tr_b16 v[64:65], v14 offset:0
    ds_read_b64_tr_b16 v[66:67], v14 offset:512
    ds_read_b64_tr_b16 v[68:69], v14 offset:1024
    ds_read_b64_tr_b16 v[70:71], v14 offset:1536
    ds_read_b64_tr_b16 v[72:73], v14 offset:2048
    ds_read_b64_tr_b16 v[74:75], v14 offset:2560
    ds_read_b64_tr_b16 v[76:77], v14 offset:3072
    ds_read_b64_tr_b16 v[78:79], v14 offset:3584
    ds_read_b64_tr_b16 v[80:81], v14 offset:4096
    ds_read_b64_tr_b16 v[82:83], v14 offset:4608
    ds_read_b64_tr_b16 v[84:85], v14 offset:5120
    ds_read_b64_tr_b16 v[86:87], v14 offset:5632
    s_waitcnt lgkmcnt(4)
    ds_read_b64_tr_b16 v[88:89], v14 offset:6144
    ds_read_b64_tr_b16 v[90:91], v14 offset:6656
    ds_read_b64_tr_b16 v[92:93], v14 offset:7168
    ds_read_b64_tr_b16 v[94:95], v14 offset:7680
    s_waitcnt lgkmcnt(0)
    v_mfma_f32_16x16x32_bf16 v[60:63], v[64:67], v[48:51], v[60:63]
    v_mfma_f32_16x16x32_bf16 v[60:63], v[68:71], v[48:51], v[60:63]
    v_mfma_f32_16x16x32_bf16 v[60:63], v[72:75], v[48:51], v[60:63]
    v_mfma_f32_16x16x32_bf16 v[60:63], v[76:79], v[48:51], v[60:63]
    v_mfma_f32_16x16x32_bf16 v[60:63], v[80:83], v[48:51], v[60:63]
    v_mfma_f32_16x16x32_bf16 v[60:63], v[84:87], v[48:51], v[60:63]
    v_mfma_f32_16x16x32_bf16 v[60:63], v[88:91], v[48:51], v[60:63]
    v_mfma_f32_16x16x32_bf16 v[60:63], v[92:95], v[48:51], v[60:63]
    v_mov_b32 v55, 0x3727c5ac
    v_lshlrev_b32 v10, 4, v0
    v_bfe_u32 v11, v0, 0, 2
    v_lshlrev_b32 v11, 10, v11
    v_bfe_u32 v15, v0, 5, 1
    v_lshl_add_u32 v11, v15, 8, v11
    v_bfe_u32 v15, v0, 4, 1
    v_lshl_add_u32 v11, v15, 3, v11
    s_add_u32 s46, s35, 90112
    s_bfe_u32 s33, s5, 131073
    s_lshl_b32 s33, s33, 6
    s_add_u32 s47, s35, s33
    s_bfe_u32 s33, s5, 65536
    s_lshl_b32 s33, s33, 9
    s_add_u32 s47, s47, s33
    s_bfe_u32 s33, s5, 131075
    s_lshl_b32 s33, s33, 4
    s_add_u32 s47, s47, s33
    s_add_u32 s47, s47, 94208
    s_mov_b32 s37, 1
    s_add_u32 s35, s35, 131072
    s_mov_b32 s42, 131072
    s_add_u32 s8, s8, -12288
    s_add_u32 s9, s9, 131072
    s_add_u32 s10, s10, 131072
    s_add_u32 s11, s11, 131072
    s_add_u32 s60, s60, 131072
    s_add_u32 s63, s63, 131072
    s_add_u32 s40, s40, 131072
    s_barrier
    s_barrier
    s_barrier
    s_barrier
L_S4B:
    buffer_load_dwordx4 v[16:19], v10, s[16:19], s46 offen offset:0 sc1
    buffer_load_dwordx4 v[20:23], v10, s[16:19], s46 offen offset:1024 sc1
    buffer_load_dwordx4 v[24:27], v10, s[16:19], s46 offen offset:2048 sc1
    buffer_load_dwordx4 v[28:31], v10, s[16:19], s46 offen offset:3072 sc1
    s_sleep 3
Lp_34:
    buffer_load_dwordx4 v[16:19], v10, s[16:19], s46 offen offset:0 sc1
    buffer_load_dwordx4 v[20:23], v10, s[16:19], s46 offen offset:1024 sc1
    buffer_load_dwordx4 v[24:27], v10, s[16:19], s46 offen offset:2048 sc1
    buffer_load_dwordx4 v[28:31], v10, s[16:19], s46 offen offset:3072 sc1
    s_sub_u32 s43, s43, 1
    s_cbranch_scc1 Lgu_36
Lpk_35:
    s_waitcnt vmcnt(7)
    v_max3_u32 v54, v16, v17, v18
    v_max_u32 v54, v54, v19
    v_mfma_f32_16x16x32_bf16 v[32:35], v[64:67], v[16:19], 0
    s_waitcnt vmcnt(6)
    v_max3_u32 v54, v54, v20, v21
    v_max3_u32 v54, v54, v22, v23
    v_mfma_f32_16x16x32_bf16 v[36:39], v[68:71], v[16:19], 0
    s_waitcnt vmcnt(5)
    v_max3_u32 v54, v54, v24, v25
    v_max3_u32 v54, v54, v26, v27
    v_mfma_f32_16x16x32_bf16 v[40:43], v[72:75], v[16:19], 0
    s_waitcnt vmcnt(4)
    v_max3_u32 v54, v54, v28, v29
    v_max3_u32 v54, v54, v30, v31
    v_cmp_eq_u32 vcc, -1, v54
    s_and_b64 vcc, vcc, s[0:1]
    s_cbranch_scc1 Lp_34
    v_mov_b32 v53, 0
    v_dot2c_f32_bf16 v53, v16, v16
    v_dot2c_f32_bf16 v53, v17, v17
    v_dot2c_f32_bf16 v53, v18, v18
    v_dot2c_f32_bf16 v53, v19, v19
    v_dot2c_f32_bf16 v53, v20, v20
    v_dot2c_f32_bf16 v53, v21, v21
    v_dot2c_f32_bf16 v53, v22, v22
    v_dot2c_f32_bf16 v53, v23, v23
    v_dot2c_f32_bf16 v53, v24, v24
    v_dot2c_f32_bf16 v53, v25, v25
    v_dot2c_f32_bf16 v53, v26, v26
    v_dot2c_f32_bf16 v53, v27, v27
    v_dot2c_f32_bf16 v53, v28, v28
    v_dot2c_f32_bf16 v53, v29, v29
    v_dot2c_f32_bf16 v53, v30, v30
    v_dot2c_f32_bf16 v53, v31, v31
    v_mfma_f32_16x16x32_bf16 v[44:47], v[76:79], v[16:19], 0
    ds_read_b64_tr_b16 v[64:65], v14 offset:8192
    ds_read_b64_tr_b16 v[66:67], v14 offset:8704
    ds_read_b64_tr_b16 v[68:69], v14 offset:9216
    ds_read_b64_tr_b16 v[70:71], v14 offset:9728
    v_mfma_f32_16x16x32_bf16 v[56:59], v[48:51], v[16:19], 0
    ds_read_b64_tr_b16 v[72:73], v14 offset:10240
    ds_read_b64_tr_b16 v[74:75], v14 offset:10752
    ds_read_b64_tr_b16 v[76:77], v14 offset:11264
    ds_read_b64_tr_b16 v[78:79], v14 offset:11776
    v_mfma_f32_16x16x32_bf16 v[32:35], v[80:83], v[20:23], v[32:35]
    ds_read_b64_tr_b16 v[80:81], v14 offset:12288
    ds_read_b64_tr_b16 v[82:83], v14 offset:12800
    v_mfma_f32_16x16x32_bf16 v[56:59], v[48:51], v[20:23], v[56:59]
    s_cmp_eq_u32 s36, 0
    v_mfma_f32_16x16x32_bf16 v[36:39], v[84:87], v[20:23], v[36:39]
    ds_read_b64_tr_b16 v[84:85], v14 offset:13312
    ds_read_b64_tr_b16 v[86:87], v14 offset:13824
    v_mfma_f32_16x16x32_bf16 v[56:59], v[48:51], v[24:27], v[56:59]
    v_mfma_f32_16x16x32_bf16 v[40:43], v[88:91], v[20:23], v[40:43]
    ds_read_b64_tr_b16 v[88:89], v14 offset:14336
    ds_read_b64_tr_b16 v[90:91], v14 offset:14848
    v_mfma_f32_16x16x32_bf16 v[56:59], v[48:51], v[28:31], v[56:59]
    v_add_f32_dpp v54, v53, v53 row_shl:4 row_mask:0xf bank_mask:0xf
    v_add_f32_dpp v54, v53, v54 row_shl:8 row_mask:0xf bank_mask:0xf
    v_mfma_f32_16x16x32_bf16 v[44:47], v[92:95], v[20:23], v[44:47]
    s_waitcnt lgkmcnt(12)
    ds_read_b64_tr_b16 v[92:93], v14 offset:15360
    ds_read_b64_tr_b16 v[94:95], v14 offset:15872
    s_waitcnt lgkmcnt(10)
    v_mfma_f32_16x16x32_bf16 v[32:35], v[64:67], v[24:27], v[32:35]
    v_add_f32_dpp v54, v53, v54 row_shl:12 row_mask:0xf bank_mask:0xf
    v_mov_b32 v53, v54
    v_mfma_f32_16x16x32_bf16 v[36:39], v[68:71], v[24:27], v[36:39]
    s_nop 0
    v_permlane16_swap_b32 v54, v53
    v_mfma_f32_16x16x32_bf16 v[40:43], v[72:75], v[24:27], v[40:43]
    v_add_f32 v54, v54, v53
    v_mov_b32 v53, v54
    s_waitcnt lgkmcnt(4)
    v_mfma_f32_16x16x32_bf16 v[44:47], v[76:79], v[24:27], v[44:47]
    s_nop 0
    v_permlane32_swap_b32 v54, v53
    v_mfma_f32_16x16x32_bf16 v[32:35], v[80:83], v[28:31], v[32:35]
    v_add_f32 v54, v54, v53
    v_fmamk_f32 v54, v54, 0x3b000000, v55
    v_mfma_f32_16x16x32_bf16 v[36:39], v[84:87], v[28:31], v[36:39]
    v_add_f32_dpp v52, v56, v56 row_shl:4 row_mask:0xf bank_mask:0xf
    v_add_f32_dpp v52, v56, v52 row_shl:8 row_mask:0xf bank_mask:0xf
    s_waitcnt lgkmcnt(0)
    v_mfma_f32_16x16x32_bf16 v[40:43], v[88:91], v[28:31], v[40:43]
    v_add_f32_dpp v52, v56, v52 row_shl:12 row_mask:0xf bank_mask:0xf
    v_mul_f32 v52, 0x3b000000, v52
    v_mfma_f32_16x16x32_bf16 v[44:47], v[92:95], v[28:31], v[44:47]
    v_fma_f32 v54, -v52, v52, v54
    v_max_f32 v54, v54, v55
    v_rsq_f32 v54, v54
    s_nop 2
    v_add_f32_dpp v48, v36, v32 row_shl:4 row_mask:0xf bank_mask:0xf
    v_add_f32_dpp v49, v37, v33 row_shl:4 row_mask:0xf bank_mask:0xf
    v_add_f32_dpp v50, v38, v34 row_shl:4 row_mask:0xf bank_mask:0xf
    v_add_f32_dpp v51, v39, v35 row_shl:4 row_mask:0xf bank_mask:0xf
    v_add_f32_dpp v48, v40, v48 row_shl:8 row_mask:0xf bank_mask:0xf
    v_add_f32_dpp v49, v41, v49 row_shl:8 row_mask:0xf bank_mask:0xf
    v_add_f32_dpp v50, v42, v50 row_shl:8 row_mask:0xf bank_mask:0xf
    v_add_f32_dpp v51, v43, v51 row_shl:8 row_mask:0xf bank_mask:0xf
    v_add_f32_dpp v48, v44, v48 row_shl:12 row_mask:0xf bank_mask:0xf
    v_add_f32_dpp v49, v45, v49 row_shl:12 row_mask:0xf bank_mask:0xf
    v_add_f32_dpp v50, v46, v50 row_shl:12 row_mask:0xf bank_mask:0xf
    v_add_f32_dpp v51, v47, v51 row_shl:12 row_mask:0xf bank_mask:0xf
    v_pk_fma_f32 v[48:49], v[52:53], v[60:61], v[48:49] op_sel_hi:[0,1,1] neg_lo:[1,0,0] neg_hi:[1,0,0]
    v_pk_fma_f32 v[50:51], v[52:53], v[62:63], v[50:51] op_sel_hi:[0,1,1] neg_lo:[1,0,0] neg_hi:[1,0,0]
    v_pk_mul_f32 v[48:49], v[48:49], v[54:55] op_sel_hi:[1,0]
    v_pk_mul_f32 v[50:51], v[50:51], v[54:55] op_sel_hi:[1,0]
    v_cvt_pk_bf16_f32 v48, v48, v49
    v_cvt_pk_bf16_f32 v49, v50, v51
    s_mov_b64 exec, s[38:39]
    s_cbranch_scc1 Ls_37
    buffer_store_dwordx2 v[48:49], v11, s[16:19], s47 offen
Ls_38:
    s_mov_b64 exec, -1
    s_barrier
    s_branch L_QPOLL0
L_W1:
    v_lshlrev_b32 v10, 4, v0
    v_lshlrev_b32 v14, 3, v0
    v_add_u32 v14, 24576, v14
    v_bfe_u32 v11, v0, 3, 1
    v_lshlrev_b32 v11, 8, v11
    v_bfe_u32 v15, v0, 0, 2
    v_lshl_add_u32 v11, v15, 4, v11
    v_bfe_u32 v15, v0, 2, 1
    v_lshl_add_u32 v11, v15, 3, v11
    v_bfe_u32 v15, v0, 5, 1
    v_lshl_add_u32 v11, v15, 2, v11
    s_cmp_lg_u32 s37, 0
    s_cbranch_scc1 Lres_39
    v_bfe_u32 v12, v0, 0, 2
    v_lshlrev_b32 v12, 10, v12
    v_bfe_u32 v15, v0, 2, 2
    v_lshl_add_u32 v12, v15, 3, v12
    v_bfe_u32 v15, v0, 5, 1
    v_lshl_add_u32 v12, v15, 2, v12
    s_lshl_b32 s33, s5, 5
    buffer_load_dword v58, v12, s[20:23], s33 offen
    v_cmp_eq_u32 vcc, 32, v13
    s_bcnt1_i32_b64 s47, vcc
    s_cmp_eq_u32 s47, 8
    s_cbranch_scc0 Lca_41
Lcad_42:
    s_branch Lres_40
Lres_39:
    s_bfe_u32 s33, s5, 131075
    s_lshl_b32 s33, s33, 10
    s_add_u32 s47, s35, s33
    s_bfe_u32 s33, s5, 65536
    s_lshl_b32 s33, s33, 9
    s_add_u32 s47, s47, s33
    s_bfe_u32 s33, s5, 131073
    s_lshl_b32 s33, s33, 6
    s_add_u32 s47, s47, s33
    s_add_u32 s47, s47, -40960
    buffer_load_dword v58, v11, s[16:19], s47 offen sc1
Lres_40:
    s_add_u32 s46, s35, 81920
    s_lshl_b32 s33, s5, 8
    s_add_u32 s47, s33, s35
    s_add_u32 s47, s47, 0
    s_waitcnt lgkmcnt(0)
    s_waitcnt vmcnt(0)
    s_barrier
    ds_read_b64_tr_b16 v[64:65], v14 offset:0
    ds_read_b64_tr_b16 v[66:67], v14 offset:512
    ds_read_b64_tr_b16 v[68:69], v14 offset:1024
    ds_read_b64_tr_b16 v[70:71], v14 offset:1536
    ds_read_b64_tr_b16 v[72:73], v14 offset:2048
    ds_read_b64_tr_b16 v[74:75], v14 offset:2560
    ds_read_b64_tr_b16 v[76:77], v14 offset:3072
    ds_read_b64_tr_b16 v[78:79], v14 offset:3584
    s_waitcnt lgkmcnt(4)
    buffer_load_dwordx4 v[16:19], v10, s[16:19], s46 offen offset:0 sc1
    buffer_load_dwordx4 v[20:23], v10, s[16:19], s46 offen offset:1024 sc1
    buffer_load_dwordx4 v[24:27], v10, s[16:19], s46 offen offset:2048 sc1
    buffer_load_dwordx4 v[28:31], v10, s[16:19], s46 offen offset:3072 sc1
    ds_read_b64_tr_b16 v[80:81], v14 offset:4096
    ds_read_b64_tr_b16 v[82:83], v14 offset:4608
    ds_read_b64_tr_b16 v[84:85], v14 offset:5120
    ds_read_b64_tr_b16 v[86:87], v14 offset:5632
    ds_read_b64_tr_b16 v[88:89], v14 offset:6144
    ds_read_b64_tr_b16 v[90:91], v14 offset:6656
    ds_read_b64_tr_b16 v[92:93], v14 offset:7168
    ds_read_b64_tr_b16 v[94:95], v14 offset:7680
    s_waitcnt lgkmcnt(0)
Lp_43:
    buffer_load_dwordx4 v[16:19], v10, s[16:19], s46 offen offset:0 sc1
    buffer_load_dwordx4 v[20:23], v10, s[16:19], s46 offen offset:1024 sc1
    buffer_load_dwordx4 v[24:27], v10, s[16:19], s46 offen offset:2048 sc1
    buffer_load_dwordx4 v[28:31], v10, s[16:19], s46 offen offset:3072 sc1
    s_sub_u32 s43, s43, 1
    s_cbranch_scc1 Lgu_45
Lpk_44:
    s_waitcnt vmcnt(7)
    v_max3_u32 v54, v16, v17, v18
    v_max_u32 v54, v54, v19
    v_mfma_f32_16x16x32_bf16 v[32:35], v[64:67], v[16:19], 0
    s_waitcnt vmcnt(6)
    v_max3_u32 v54, v54, v20, v21
    v_max3_u32 v54, v54, v22, v23
    v_mfma_f32_16x16x32_bf16 v[36:39], v[68:71], v[16:19], 0
    s_waitcnt vmcnt(5)
    v_max3_u32 v54, v54, v24, v25
    v_max3_u32 v54, v54, v26, v27
    v_mfma_f32_16x16x32_bf16 v[40:43], v[72:75], v[16:19], 0
    s_waitcnt vmcnt(4)
    v_max3_u32 v54, v54, v28, v29
    v_max3_u32 v54, v54, v30, v31
    v_cmp_eq_u32 vcc, -1, v54
    s_and_b64 vcc, vcc, s[0:1]
    s_cbranch_scc1 Lp_43
    v_mfma_f32_16x16x32_bf16 v[44:47], v[76:79], v[16:19], 0
    ds_read_b64_tr_b16 v[64:65], v14 offset:32768
    ds_read_b64_tr_b16 v[66:67], v14 offset:33280
    ds_read_b64_tr_b16 v[68:69], v14 offset:33792
    ds_read_b64_tr_b16 v[70:71], v14 offset:34304
    v_mfma_f32_16x16x32_bf16 v[32:35], v[80:83], v[20:23], v[32:35]
    ds_read_b64_tr_b16 v[72:73], v14 offset:34816
    ds_read_b64_tr_b16 v[74:75], v14 offset:35328
    ds_read_b64_tr_b16 v[76:77], v14 offset:35840
    ds_read_b64_tr_b16 v[78:79], v14 offset:36352
    v_mfma_f32_16x16x32_bf16 v[36:39], v[84:87], v[20:23], v[36:39]
    ds_read_b64_tr_b16 v[80:81], v14 offset:36864
    ds_read_b64_tr_b16 v[82:83], v14 offset:37376
    v_mfma_f32_16x16x32_bf16 v[40:43], v[88:91], v[20:23], v[40:43]
    ds_read_b64_tr_b16 v[84:85], v14 offset:37888
    ds_read_b64_tr_b16 v[86:87], v14 offset:38400
    v_mfma_f32_16x16x32_bf16 v[44:47], v[92:95], v[20:23], v[44:47]
    ds_read_b64_tr_b16 v[88:89], v14 offset:38912
    ds_read_b64_tr_b16 v[90:91], v14 offset:39424
    s_waitcnt lgkmcnt(8)
    v_mfma_f32_16x16x32_bf16 v[32:35], v[64:67], v[24:27], v[32:35]
    s_waitcnt lgkmcnt(12)
    ds_read_b64_tr_b16 v[92:93], v14 offset:39936
    ds_read_b64_tr_b16 v[94:95], v14 offset:40448
    v_mfma_f32_16x16x32_bf16 v[36:39], v[68:71], v[24:27], v[36:39]
    v_mfma_f32_16x16x32_bf16 v[40:43], v[72:75], v[24:27], v[40:43]
    s_waitcnt lgkmcnt(4)
    v_mfma_f32_16x16x32_bf16 v[44:47], v[76:79], v[24:27], v[44:47]
    v_mfma_f32_16x16x32_bf16 v[32:35], v[80:83], v[28:31], v[32:35]
    v_mfma_f32_16x16x32_bf16 v[36:39], v[84:87], v[28:31], v[36:39]
    s_waitcnt lgkmcnt(0)
    v_mfma_f32_16x16x32_bf16 v[40:43], v[88:91], v[28:31], v[40:43]
    v_mfma_f32_16x16x32_bf16 v[44:47], v[92:95], v[28:31], v[44:47]
    s_nop 5
    v_add_f32_dpp v48, v36, v32 row_shl:4 row_mask:0xf bank_mask:0xf
    v_add_f32_dpp v49, v37, v33 row_shl:4 row_mask:0xf bank_mask:0xf
    v_add_f32_dpp v50, v38, v34 row_shl:4 row_mask:0xf bank_mask:0xf
    v_add_f32_dpp v51, v39, v35 row_shl:4 row_mask:0xf bank_mask:0xf
    v_add_f32_dpp v48, v40, v48 row_shl:8 row_mask:0xf bank_mask:0xf
    v_add_f32_dpp v49, v41, v49 row_shl:8 row_mask:0xf bank_mask:0xf
    v_add_f32_dpp v50, v42, v50 row_shl:8 row_mask:0xf bank_mask:0xf
    v_add_f32_dpp v51, v43, v51 row_shl:8 row_mask:0xf bank_mask:0xf
    v_add_f32_dpp v48, v44, v48 row_shl:12 row_mask:0xf bank_mask:0xf
    v_add_f32_dpp v49, v45, v49 row_shl:12 row_mask:0xf bank_mask:0xf
    v_add_f32_dpp v50, v46, v50 row_shl:12 row_mask:0xf bank_mask:0xf
    v_add_f32_dpp v51, v47, v51 row_shl:12 row_mask:0xf bank_mask:0xf
    s_mov_b64 exec, s[38:39]
    buffer_store_dwordx4 v[48:51], v8, s[16:19], s47 offen sc1
    s_barrier
    s_bfe_u32 s33, s5, 131075
    s_lshl_b32 s33, s33, 10
    s_add_u32 s47, s35, s33
    s_bfe_u32 s33, s5, 65536
    s_lshl_b32 s33, s33, 9
    s_add_u32 s47, s47, s33
    s_bfe_u32 s33, s5, 131073
    s_lshl_b32 s33, s33, 6
    s_add_u32 s47, s47, s33
    s_add_u32 s47, s47, 86016
    s_mov_b64 exec, -1
    s_lshl_b32 s33, s5, 8
    s_add_u32 s33, s33, s42
    s_add_u32 s48, s33, 0
    s_add_u32 s49, s48, 1048576
    v_bfe_u32 v10, v0, 4, 2
    v_lshlrev_b32 v10, 18, v10
    v_bfe_u32 v15, v0, 0, 4
    v_lshl_add_u32 v10, v15, 4, v10
    v_lshlrev_b32 v54, 16, v58
    v_and_b32 v55, 0xffff0000, v58
    s_sleep 10
L_B1:
    buffer_load_dwordx4 v[16:19], v10, s[16:19], s48 offen sc1
    buffer_load_dwordx4 v[20:23], v10, s[16:19], s49 offen sc1
    s_sub_u32 s43, s43, 1
    s_cbranch_scc1 Lgu_47
Lpk_46:
    s_waitcnt vmcnt(0)
    v_pk_add_f32 v[48:49], v[16:17], v[20:21]
    v_pk_add_f32 v[50:51], v[18:19], v[22:23]
    s_nop 1
    v_permlane32_swap_b32 v48, v50
    v_permlane32_swap_b32 v49, v51
    v_pk_add_f32 v[48:49], v[48:49], v[50:51]
    v_mov_b32 v50, v48
    v_mov_b32 v51, v49
    s_nop 0
    v_permlane16_swap_b32 v48, v50
    v_permlane16_swap_b32 v49, v51
    v_pk_add_f32 v[48:49], v[48:49], v[50:51]
    v_pk_add_f32 v[48:49], v[48:49], v[54:55]
    v_cmp_u_f32 vcc, v48, v49
    s_and_b64 vcc, vcc, s[0:1]
    s_cbranch_scc1 L_B1
    v_cvt_pk_bf16_f32 v48, v48, v49
    s_cmp_eq_u32 s36, 0
    s_cbranch_scc1 Ls_48
    buffer_store_dword v48, v11, s[16:19], s47 offen
Ls_49:
    s_barrier
    s_cmp_lg_u32 s37, 0
    s_cbranch_scc1 L_FIN
    s_barrier
    s_barrier
    s_mov_b32 s37, 1
    s_add_u32 s35, s35, 131072
    s_mov_b32 s42, 131072
    s_add_u32 s8, s8, -12288
    s_add_u32 s9, s9, 131072
    s_add_u32 s10, s10, 131072
    s_add_u32 s11, s11, 131072
    s_add_u32 s60, s60, 131072
    s_add_u32 s63, s63, 131072
    s_add_u32 s40, s40, 131072
    s_barrier
    s_branch L_QPOLL0
L_W2:
    v_lshlrev_b32 v10, 4, v0
    v_bfe_u32 v11, v0, 0, 2
    v_lshlrev_b32 v11, 4, v11
    v_bfe_u32 v15, v0, 4, 1
    v_lshl_add_u32 v11, v15, 3, v11
    v_bfe_u32 v15, v0, 5, 1
    v_lshl_add_u32 v11, v15, 2, v11
    v_lshlrev_b32 v14, 3, v0
    v_add_u32 v14, 90112, v14
    s_add_u32 s46, s35, 86016
    s_bfe_u32 s33, s74, 65540
    s_lshl_b32 s33, s33, 10
    s_add_u32 s47, s35, s33
    s_bfe_u32 s33, s74, 131072
    s_lshl_b32 s33, s33, 8
    s_add_u32 s47, s47, s33
    s_bfe_u32 s33, s74, 131074
    s_lshl_b32 s33, s33, 6
    s_add_u32 s47, s47, s33
    s_add_u32 s47, s47, 100352
    s_waitcnt vmcnt(0)
    v_mov_b32 v48, s44
    v_mov_b32 v49, s44
    v_mov_b32 v50, s44
    v_mov_b32 v51, s44
    ds_read_b64_tr_b16 v[64:65], v14 offset:32768
    ds_read_b64_tr_b16 v[66:67], v14 offset:33280
    ds_read_b64_tr_b16 v[68:69], v14 offset:33792
    ds_read_b64_tr_b16 v[70:71], v14 offset:34304
    ds_read_b64_tr_b16 v[72:73], v14 offset:34816
    ds_read_b64_tr_b16 v[74:75], v14 offset:35328
    ds_read_b64_tr_b16 v[76:77], v14 offset:35840
    ds_read_b64_tr_b16 v[78:79], v14 offset:36352
    ds_read_b64_tr_b16 v[80:81], v14 offset:36864
    ds_read_b64_tr_b16 v[82:83], v14 offset:37376
    ds_read_b64_tr_b16 v[84:85], v14 offset:37888
    ds_read_b64_tr_b16 v[86:87], v14 offset:38400
    s_waitcnt lgkmcnt(4)
    ds_read_b64_tr_b16 v[88:89], v14 offset:38912
    ds_read_b64_tr_b16 v[90:91], v14 offset:39424
    ds_read_b64_tr_b16 v[92:93], v14 offset:39936
    ds_read_b64_tr_b16 v[94:95], v14 offset:40448
    s_waitcnt lgkmcnt(0)
    v_mfma_f32_16x16x32_bf16 v[60:63], v[64:67], v[48:51], 0
    v_mfma_f32_16x16x32_bf16 v[60:63], v[68:71], v[48:51], v[60:63]
    v_mfma_f32_16x16x32_bf16 v[60:63], v[72:75], v[48:51], v[60:63]
    v_mfma_f32_16x16x32_bf16 v[60:63], v[76:79], v[48:51], v[60:63]
    v_mfma_f32_16x16x32_bf16 v[60:63], v[80:83], v[48:51], v[60:63]
    v_mfma_f32_16x16x32_bf16 v[60:63], v[84:87], v[48:51], v[60:63]
    v_mfma_f32_16x16x32_bf16 v[60:63], v[88:91], v[48:51], v[60:63]
    v_mfma_f32_16x16x32_bf16 v[60:63], v[92:95], v[48:51], v[60:63]
    ds_read_b64_tr_b16 v[64:65], v14 offset:0
    ds_read_b64_tr_b16 v[66:67], v14 offset:512
    ds_read_b64_tr_b16 v[68:69], v14 offset:1024
    ds_read_b64_tr_b16 v[70:71], v14 offset:1536
    ds_read_b64_tr_b16 v[72:73], v14 offset:2048
    ds_read_b64_tr_b16 v[74:75], v14 offset:2560
    ds_read_b64_tr_b16 v[76:77], v14 offset:3072
    ds_read_b64_tr_b16 v[78:79], v14 offset:3584
    ds_read_b64_tr_b16 v[80:81], v14 offset:4096
    ds_read_b64_tr_b16 v[82:83], v14 offset:4608
    ds_read_b64_tr_b16 v[84:85], v14 offset:5120
    ds_read_b64_tr_b16 v[86:87], v14 offset:5632
    s_waitcnt lgkmcnt(4)
    ds_read_b64_tr_b16 v[88:89], v14 offset:6144
    ds_read_b64_tr_b16 v[90:91], v14 offset:6656
    ds_read_b64_tr_b16 v[92:93], v14 offset:7168
    ds_read_b64_tr_b16 v[94:95], v14 offset:7680
    s_waitcnt lgkmcnt(0)
    v_mfma_f32_16x16x32_bf16 v[60:63], v[64:67], v[48:51], v[60:63]
    v_mfma_f32_16x16x32_bf16 v[60:63], v[68:71], v[48:51], v[60:63]
    v_mfma_f32_16x16x32_bf16 v[60:63], v[72:75], v[48:51], v[60:63]
    v_mfma_f32_16x16x32_bf16 v[60:63], v[76:79], v[48:51], v[60:63]
    v_mfma_f32_16x16x32_bf16 v[60:63], v[80:83], v[48:51], v[60:63]
    v_mfma_f32_16x16x32_bf16 v[60:63], v[84:87], v[48:51], v[60:63]
    v_mfma_f32_16x16x32_bf16 v[60:63], v[88:91], v[48:51], v[60:63]
    v_mfma_f32_16x16x32_bf16 v[60:63], v[92:95], v[48:51], v[60:63]
    v_mov_b32 v55, 0x3727c5ac
    s_barrier
    s_barrier
    s_barrier
    s_cmp_ge_u32 s74, 28
    s_cbranch_scc1 L_S2D
L_S2B:
    buffer_load_dwordx4 v[16:19], v10, s[16:19], s46 offen offset:0 sc1
    buffer_load_dwordx4 v[20:23], v10, s[16:19], s46 offen offset:1024 sc1
    buffer_load_dwordx4 v[24:27], v10, s[16:19], s46 offen offset:2048 sc1
    buffer_load_dwordx4 v[28:31], v10, s[16:19], s46 offen offset:3072 sc1
    s_sleep 3
Lp_50:
    buffer_load_dwordx4 v[16:19], v10, s[16:19], s46 offen offset:0 sc1
    buffer_load_dwordx4 v[20:23], v10, s[16:19], s46 offen offset:1024 sc1
    buffer_load_dwordx4 v[24:27], v10, s[16:19], s46 offen offset:2048 sc1
    buffer_load_dwordx4 v[28:31], v10, s[16:19], s46 offen offset:3072 sc1
    s_sub_u32 s43, s43, 1
    s_cbranch_scc1 Lgu_52
Lpk_51:
    s_waitcnt vmcnt(7)
    v_max3_u32 v54, v16, v17, v18
    v_max_u32 v54, v54, v19
    v_mfma_f32_16x16x32_bf16 v[32:35], v[64:67], v[16:19], 0
    s_waitcnt vmcnt(6)
    v_max3_u32 v54, v54, v20, v21
    v_max3_u32 v54, v54, v22, v23
    v_mfma_f32_16x16x32_bf16 v[36:39], v[68:71], v[16:19], 0
    s_waitcnt vmcnt(5)
    v_max3_u32 v54, v54, v24, v25
    v_max3_u32 v54, v54, v26, v27
    v_mfma_f32_16x16x32_bf16 v[40:43], v[72:75], v[16:19], 0
    s_waitcnt vmcnt(4)
    v_max3_u32 v54, v54, v28, v29
    v_max3_u32 v54, v54, v30, v31
    v_cmp_eq_u32 vcc, -1, v54
    s_and_b64 vcc, vcc, s[0:1]
    s_cbranch_scc1 Lp_50
    v_mov_b32 v53, 0
    v_dot2c_f32_bf16 v53, v16, v16
    v_dot2c_f32_bf16 v53, v17, v17
    v_dot2c_f32_bf16 v53, v18, v18
    v_dot2c_f32_bf16 v53, v19, v19
    v_dot2c_f32_bf16 v53, v20, v20
    v_dot2c_f32_bf16 v53, v21, v21
    v_dot2c_f32_bf16 v53, v22, v22
    v_dot2c_f32_bf16 v53, v23, v23
    v_dot2c_f32_bf16 v53, v24, v24
    v_dot2c_f32_bf16 v53, v25, v25
    v_dot2c_f32_bf16 v53, v26, v26
    v_dot2c_f32_bf16 v53, v27, v27
    v_dot2c_f32_bf16 v53, v28, v28
    v_dot2c_f32_bf16 v53, v29, v29
    v_dot2c_f32_bf16 v53, v30, v30
    v_dot2c_f32_bf16 v53, v31, v31
    v_mfma_f32_16x16x32_bf16 v[44:47], v[76:79], v[16:19], 0
    ds_read_b64_tr_b16 v[64:65], v14 offset:32768
    ds_read_b64_tr_b16 v[66:67], v14 offset:33280
    ds_read_b64_tr_b16 v[68:69], v14 offset:33792
    ds_read_b64_tr_b16 v[70:71], v14 offset:34304
    v_mfma_f32_16x16x32_bf16 v[56:59], v[48:51], v[16:19], 0
    ds_read_b64_tr_b16 v[72:73], v14 offset:34816
    ds_read_b64_tr_b16 v[74:75], v14 offset:35328
    ds_read_b64_tr_b16 v[76:77], v14 offset:35840
    ds_read_b64_tr_b16 v[78:79], v14 offset:36352
    v_mfma_f32_16x16x32_bf16 v[32:35], v[80:83], v[20:23], v[32:35]
    ds_read_b64_tr_b16 v[80:81], v14 offset:36864
    ds_read_b64_tr_b16 v[82:83], v14 offset:37376
    v_mfma_f32_16x16x32_bf16 v[56:59], v[48:51], v[20:23], v[56:59]
    s_cmp_eq_u32 s36, 0
    v_mfma_f32_16x16x32_bf16 v[36:39], v[84:87], v[20:23], v[36:39]
    ds_read_b64_tr_b16 v[84:85], v14 offset:37888
    ds_read_b64_tr_b16 v[86:87], v14 offset:38400
    v_mfma_f32_16x16x32_bf16 v[56:59], v[48:51], v[24:27], v[56:59]
    v_mfma_f32_16x16x32_bf16 v[40:43], v[88:91], v[20:23], v[40:43]
    ds_read_b64_tr_b16 v[88:89], v14 offset:38912
    ds_read_b64_tr_b16 v[90:91], v14 offset:39424
    v_mfma_f32_16x16x32_bf16 v[56:59], v[48:51], v[28:31], v[56:59]
    v_add_f32_dpp v54, v53, v53 row_shl:4 row_mask:0xf bank_mask:0xf
    v_add_f32_dpp v54, v53, v54 row_shl:8 row_mask:0xf bank_mask:0xf
    v_mfma_f32_16x16x32_bf16 v[44:47], v[92:95], v[20:23], v[44:47]
    s_waitcnt lgkmcnt(12)
    ds_read_b64_tr_b16 v[92:93], v14 offset:39936
    ds_read_b64_tr_b16 v[94:95], v14 offset:40448
    s_waitcnt lgkmcnt(10)
    v_mfma_f32_16x16x32_bf16 v[32:35], v[64:67], v[24:27], v[32:35]
    v_add_f32_dpp v54, v53, v54 row_shl:12 row_mask:0xf bank_mask:0xf
    v_mov_b32 v53, v54
    v_mfma_f32_16x16x32_bf16 v[36:39], v[68:71], v[24:27], v[36:39]
    s_nop 0
    v_permlane16_swap_b32 v54, v53
    v_mfma_f32_16x16x32_bf16 v[40:43], v[72:75], v[24:27], v[40:43]
    v_add_f32 v54, v54, v53
    v_mov_b32 v53, v54
    s_waitcnt lgkmcnt(4)
    v_mfma_f32_16x16x32_bf16 v[44:47], v[76:79], v[24:27], v[44:47]
    s_nop 0
    v_permlane32_swap_b32 v54, v53
    v_mfma_f32_16x16x32_bf16 v[32:35], v[80:83], v[28:31], v[32:35]
    v_add_f32 v54, v54, v53
    v_fmamk_f32 v54, v54, 0x3b000000, v55
    v_mfma_f32_16x16x32_bf16 v[36:39], v[84:87], v[28:31], v[36:39]
    v_add_f32_dpp v52, v56, v56 row_shl:4 row_mask:0xf bank_mask:0xf
    v_add_f32_dpp v52, v56, v52 row_shl:8 row_mask:0xf bank_mask:0xf
    s_waitcnt lgkmcnt(0)
    v_mfma_f32_16x16x32_bf16 v[40:43], v[88:91], v[28:31], v[40:43]
    v_add_f32_dpp v52, v56, v52 row_shl:12 row_mask:0xf bank_mask:0xf
    v_mul_f32 v52, 0x3b000000, v52
    v_mfma_f32_16x16x32_bf16 v[44:47], v[92:95], v[28:31], v[44:47]
    v_fma_f32 v54, -v52, v52, v54
    v_max_f32 v54, v54, v55
    v_rsq_f32 v54, v54
    s_nop 2
    v_add_f32_dpp v48, v36, v32 row_shl:4 row_mask:0xf bank_mask:0xf
    v_add_f32_dpp v49, v37, v33 row_shl:4 row_mask:0xf bank_mask:0xf
    v_add_f32_dpp v50, v38, v34 row_shl:4 row_mask:0xf bank_mask:0xf
    v_add_f32_dpp v51, v39, v35 row_shl:4 row_mask:0xf bank_mask:0xf
    v_add_f32_dpp v48, v40, v48 row_shl:8 row_mask:0xf bank_mask:0xf
    v_add_f32_dpp v49, v41, v49 row_shl:8 row_mask:0xf bank_mask:0xf
    v_add_f32_dpp v50, v42, v50 row_shl:8 row_mask:0xf bank_mask:0xf
    v_add_f32_dpp v51, v43, v51 row_shl:8 row_mask:0xf bank_mask:0xf
    v_add_f32_dpp v48, v44, v48 row_shl:12 row_mask:0xf bank_mask:0xf
    v_add_f32_dpp v49, v45, v49 row_shl:12 row_mask:0xf bank_mask:0xf
    v_add_f32_dpp v50, v46, v50 row_shl:12 row_mask:0xf bank_mask:0xf
    v_add_f32_dpp v51, v47, v51 row_shl:12 row_mask:0xf bank_mask:0xf
    v_pk_fma_f32 v[48:49], v[52:53], v[60:61], v[48:49] op_sel_hi:[0,1,1] neg_lo:[1,0,0] neg_hi:[1,0,0]
    v_pk_fma_f32 v[50:51], v[52:53], v[62:63], v[50:51] op_sel_hi:[0,1,1] neg_lo:[1,0,0] neg_hi:[1,0,0]
    v_pk_mul_f32 v[48:49], v[48:49], v[54:55] op_sel_hi:[1,0]
    v_pk_mul_f32 v[50:51], v[50:51], v[54:55] op_sel_hi:[1,0]
    s_nop 1
    v_permlane32_swap_b32 v48, v50
    v_permlane32_swap_b32 v49, v51
    v_max_f32 v48, 0, v48
    v_max_f32 v49, 0, v49
    v_pk_mul_f32 v[48:49], v[48:49], v[50:51]
    s_mov_b64 exec, s[38:39]
    v_cvt_pk_bf16_f32 v48, v48, v49
    s_cbranch_scc1 Ls_53
    buffer_store_dword v48, v11, s[16:19], s47 offen
Ls_54:
    s_mov_b64 exec, -1
L_S2D:
    s_barrier
    s_cmp_lg_u32 s37, 0
    s_cbranch_scc1 L_FIN
    s_barrier
    s_mov_b32 s37, 1
    s_add_u32 s35, s35, 131072
    s_mov_b32 s42, 131072
    s_add_u32 s8, s8, -12288
    s_add_u32 s9, s9, 131072
    s_add_u32 s10, s10, 131072
    s_add_u32 s11, s11, 131072
    s_add_u32 s60, s60, 131072
    s_add_u32 s63, s63, 131072
    s_add_u32 s40, s40, 131072
    s_barrier
    s_branch L_QPOLL0
L_W3:
    v_lshlrev_b32 v10, 4, v0
    v_bfe_u32 v13, v0, 2, 2
    v_cmp_eq_u32 vcc, 3, v13
    v_subrev_u32 v13, 64, v10
    s_nop 0
    v_cndmask_b32 v13, v10, v13, vcc
    v_bfe_u32 v11, v0, 3, 1
    v_lshlrev_b32 v11, 8, v11
    v_bfe_u32 v15, v0, 0, 2
    v_lshl_add_u32 v11, v15, 4, v11
    v_bfe_u32 v15, v0, 2, 1
    v_lshl_add_u32 v11, v15, 3, v11
    v_bfe_u32 v15, v0, 5, 1
    v_lshl_add_u32 v11, v15, 2, v11
    v_bfe_u32 v12, v0, 0, 2
    v_lshlrev_b32 v12, 10, v12
    v_bfe_u32 v15, v0, 2, 2
    v_lshl_add_u32 v12, v15, 3, v12
    v_bfe_u32 v15, v0, 5, 1
    v_lshl_add_u32 v12, v15, 2, v12
    v_lshlrev_b32 v14, 3, v0
    v_add_u32 v14, 147456, v14
    s_add_u32 s46, s35, 100352
    s_lshl_b32 s33, s5, 8
    s_add_u32 s47, s33, s35
    s_add_u32 s47, s47, 8192
    s_bfe_u32 s33, s5, 131075
    s_lshl_b32 s33, s33, 10
    s_add_u32 s48, s35, s33
    s_bfe_u32 s33, s5, 65536
    s_lshl_b32 s33, s33, 9
    s_add_u32 s48, s48, s33
    s_bfe_u32 s33, s5, 131073
    s_lshl_b32 s33, s33, 6
    s_add_u32 s48, s48, s33
    s_add_u32 s48, s48, 86016
    s_waitcnt vmcnt(0)
    s_barrier
    s_barrier
    s_cmp_lg_u32 s37, 0
    s_cbranch_scc1 Lc2_55
    s_cmp_ge_u32 s5, 26
    s_cbranch_scc1 Lc2_55
    v_mov_b32 v48, -1
    v_mov_b32 v49, -1
    v_mov_b32 v50, -1
    v_mov_b32 v51, -1
    s_lshl_b32 s58, s5, 12
    s_add_u32 s58, s58, s35
    s_add_u32 s58, s58, 131072
    s_cmp_lt_u32 s5, 4
    s_cbranch_scc1 Lc2_56
    s_cmp_eq_u32 s36, 0
    s_cbranch_scc1 Lc2_56
    buffer_store_dwordx4 v[48:51], v10, s[16:19], s58 offen offset:0
    buffer_store_dwordx4 v[48:51], v10, s[16:19], s58 offen offset:1024
    buffer_store_dwordx4 v[48:51], v10, s[16:19], s58 offen offset:2048
    buffer_store_dwordx4 v[48:51], v10, s[16:19], s58 offen offset:3072
    v_lshlrev_b32 v54, 6, v0
    s_waitcnt vmcnt(0)
    buffer_load_dword v55, v54, s[16:19], s58 offen sc1
    s_branch Lc2_55
Lc2_56:
    buffer_store_dwordx4 v[48:51], v10, s[16:19], s58 offen offset:0 sc1
    buffer_store_dwordx4 v[48:51], v10, s[16:19], s58 offen offset:1024 sc1
    buffer_store_dwordx4 v[48:51], v10, s[16:19], s58 offen offset:2048 sc1
    buffer_store_dwordx4 v[48:51], v10, s[16:19], s58 offen offset:3072 sc1
Lc2_55:
    s_barrier
    ds_read_b64_tr_b16 v[64:65], v14 offset:0
    ds_read_b64_tr_b16 v[66:67], v14 offset:512
    ds_read_b64_tr_b16 v[68:69], v14 offset:1024
    ds_read_b64_tr_b16 v[70:71], v14 offset:1536
    ds_read_b64_tr_b16 v[72:73], v14 offset:2048
    ds_read_b64_tr_b16 v[74:75], v14 offset:2560
    ds_read_b64_tr_b16 v[76:77], v14 offset:3072
    ds_read_b64_tr_b16 v[78:79], v14 offset:3584
    ds_read_b64_tr_b16 v[80:81], v14 offset:4096
    ds_read_b64_tr_b16 v[82:83], v14 offset:4608
    ds_read_b64_tr_b16 v[84:85], v14 offset:5120
    ds_read_b64_tr_b16 v[86:87], v14 offset:5632
    s_waitcnt lgkmcnt(4)
    ds_read_b64_tr_b16 v[88:89], v14 offset:6144
    ds_read_b64_tr_b16 v[90:91], v14 offset:6656
    s_waitcnt lgkmcnt(0)
    s_barrier
L_S3B:
    buffer_load_dword v58, v11, s[16:19], s48 offen sc1
    buffer_load_dwordx4 v[16:19], v10, s[16:19], s46 offen offset:0 sc1
    buffer_load_dwordx4 v[20:23], v13, s[16:19], s46 offen offset:1024 sc1
    s_sleep 3
Lp_57:
    buffer_load_dword v58, v11, s[16:19], s48 offen sc1
    buffer_load_dwordx4 v[16:19], v10, s[16:19], s46 offen offset:0 sc1
    buffer_load_dwordx4 v[20:23], v13, s[16:19], s46 offen offset:1024 sc1
    s_sub_u32 s43, s43, 1
    s_cbranch_scc1 Lgu_59
Lpk_58:
    s_waitcnt vmcnt(4)
    v_max3_u32 v54, v16, v17, v18
    v_max3_u32 v54, v54, v19, v58
    v_mfma_f32_16x16x32_bf16 v[32:35], v[64:67], v[16:19], 0
    s_waitcnt vmcnt(3)
    v_max3_u32 v54, v54, v20, v21
    v_max3_u32 v54, v54, v22, v23
    v_cmp_eq_u32 vcc, -1, v54
    s_and_b64 vcc, vcc, s[0:1]
    s_cbranch_scc1 Lp_57
    v_mfma_f32_16x16x32_bf16 v[36:39], v[68:71], v[16:19], 0
    v_mfma_f32_16x16x32_bf16 v[40:43], v[72:75], v[16:19], 0
    v_mfma_f32_16x16x32_bf16 v[44:47], v[76:79], v[16:19], 0
    v_mfma_f32_16x16x32_bf16 v[32:35], v[80:83], v[20:23], v[32:35]
    v_mfma_f32_16x16x32_bf16 v[36:39], v[84:87], v[20:23], v[36:39]
    v_mfma_f32_16x16x32_bf16 v[40:43], v[88:91], v[20:23], v[40:43]
    s_nop 6
    v_add_f32_dpp v48, v36, v32 row_shl:4 row_mask:0xf bank_mask:0xf
    v_add_f32_dpp v49, v37, v33 row_shl:4 row_mask:0xf bank_mask:0xf
    v_add_f32_dpp v50, v38, v34 row_shl:4 row_mask:0xf bank_mask:0xf
    v_add_f32_dpp v51, v39, v35 row_shl:4 row_mask:0xf bank_mask:0xf
    v_add_f32_dpp v48, v40, v48 row_shl:8 row_mask:0xf bank_mask:0xf
    v_add_f32_dpp v49, v41, v49 row_shl:8 row_mask:0xf bank_mask:0xf
    v_add_f32_dpp v50, v42, v50 row_shl:8 row_mask:0xf bank_mask:0xf
    v_add_f32_dpp v51, v43, v51 row_shl:8 row_mask:0xf bank_mask:0xf
    v_add_f32_dpp v48, v44, v48 row_shl:12 row_mask:0xf bank_mask:0xf
    v_add_f32_dpp v49, v45, v49 row_shl:12 row_mask:0xf bank_mask:0xf
    v_add_f32_dpp v50, v46, v50 row_shl:12 row_mask:0xf bank_mask:0xf
    v_add_f32_dpp v51, v47, v51 row_shl:12 row_mask:0xf bank_mask:0xf
    s_mov_b64 exec, s[38:39]
    buffer_store_dwordx4 v[48:51], v8, s[16:19], s47 offen sc1
    s_lshl_b32 s47, s5, 5
    s_cmp_eq_u32 s37, 0
    s_cbranch_scc1 Ld1_60
    s_cmp_lg_u32 s4, 0
    s_cbranch_scc1 L_FIN
Ld1_60:
    s_sub_u32 s46, s48, -4096
    s_mov_b64 exec, -1
    s_lshl_b32 s33, s5, 8
    s_add_u32 s33, s33, s42
    s_add_u32 s48, s33, 8192
    s_add_u32 s49, s48, 1048576
    v_bfe_u32 v10, v0, 4, 2
    v_lshlrev_b32 v10, 18, v10
    v_bfe_u32 v15, v0, 0, 4
    v_lshl_add_u32 v10, v15, 4, v10
    v_lshlrev_b32 v54, 16, v58
    v_and_b32 v55, 0xffff0000, v58
    s_sleep 10
L_D1:
    buffer_load_dwordx4 v[16:19], v10, s[16:19], s48 offen sc1
    buffer_load_dwordx4 v[20:23], v10, s[16:19], s49 offen sc1
    s_sub_u32 s43, s43, 1
    s_cbranch_scc1 Lgu_62
Lpk_61:
    s_waitcnt vmcnt(0)
    v_pk_add_f32 v[48:49], v[16:17], v[20:21]
    v_pk_add_f32 v[50:51], v[18:19], v[22:23]
    s_nop 1
    v_permlane32_swap_b32 v48, v50
    v_permlane32_swap_b32 v49, v51
    v_pk_add_f32 v[48:49], v[48:49], v[50:51]
    v_mov_b32 v50, v48
    v_mov_b32 v51, v49
    s_nop 0
    v_permlane16_swap_b32 v48, v50
    v_permlane16_swap_b32 v49, v51
    v_pk_add_f32 v[48:49], v[48:49], v[50:51]
    v_pk_add_f32 v[48:49], v[48:49], v[54:55]
    v_cmp_u_f32 vcc, v48, v49
    s_and_b64 vcc, vcc, s[0:1]
    s_cbranch_scc1 L_D1
    v_cvt_pk_bf16_f32 v48, v48, v49
    s_cmp_lg_u32 s37, 0
    s_cbranch_scc1 L_OUT
    s_cmp_eq_u32 s36, 0
    s_cbranch_scc1 Ls_63
    buffer_store_dword v48, v11, s[16:19], s46 offen
Ls_64:
    s_barrier
    s_mov_b32 s37, 1
    s_add_u32 s35, s35, 131072
    s_mov_b32 s42, 131072
    s_add_u32 s8, s8, -12288
    s_add_u32 s9, s9, 131072
    s_add_u32 s10, s10, 131072
    s_add_u32 s11, s11, 131072
    s_add_u32 s60, s60, 131072
    s_add_u32 s63, s63, 131072
    s_add_u32 s40, s40, 131072
    s_barrier
    s_branch L_QPOLL0
L_OUT:
    buffer_store_dword v48, v12, s[28:31], s47 offen
L_FIN:
L_END:
    s_endpgm
Lcks_10:
    v_mov_b32 v11, v14
    s_nop 1
    v_add_u32_dpp v11, v11, v11 quad_perm:[1,0,3,2] row_mask:0xf bank_mask:0xf
    s_nop 1
    v_add_u32_dpp v11, v11, v11 quad_perm:[2,3,0,1] row_mask:0xf bank_mask:0xf
    s_nop 1
    v_add_u32_dpp v11, v11, v11 row_half_mirror row_mask:0xf bank_mask:0xf
    s_lshl_b32 s33, s4, 3
    s_nop 0
    v_readlane_b32 s33, v11, s33
    s_nop 3
    s_cmp_ge_u32 s33, 32
    s_cbranch_scc1 Lckd_9
    s_cmp_eq_u32 s43, 0
    s_cbranch_scc1 Lckd_9
    s_sub_u32 s43, s43, 1
    s_sleep 4
    buffer_load_dword v14, v10, s[24:27], 0 offen sc1
    s_waitcnt vmcnt(0)
    s_branch Lck_8
Ls_15:
    buffer_store_dwordx2 v[48:49], v11, s[16:19], s46 offen sc1
    s_branch Ls_16
Lgu_21:
    s_mov_b32 s43, 0
    s_mov_b64 s[0:1], 0
    s_branch Lpk_20
Ls_23:
    buffer_store_dword v10, v12, s[16:19], s10 offen sc1
    s_branch Ls_24
L_STRETRY:
    s_cmp_eq_u32 s43, 0
    s_cbranch_scc1 L_STDONE
    s_sub_u32 s43, s43, 1
    buffer_load_dword v1, v12, s[16:19], s9 offen sc1
    buffer_load_dword v2, v12, s[16:19], s9 offen offset:256 sc1
    s_waitcnt vmcnt(0)
    v_max_u32 v11, v1, v2
    v_max_f32 v1, v1, v2
    v_cmp_eq_u32 vcc, -1, v11
    s_cbranch_vccnz L_STRETRY
L_STDONE:
    s_nop 1
    v_max_f32_dpp v1, v1, v1 row_ror:4 row_mask:0xf bank_mask:0xf
    s_nop 1
    v_max_f32_dpp v1, v1, v1 row_ror:8 row_mask:0xf bank_mask:0xf
    v_mov_b32 v2, v1
    s_nop 1
    v_permlane16_swap_b32 v1, v2
    v_max_f32 v1, v1, v2
    s_branch L_MRED_OK
Lpa_28:
    buffer_store_dwordx2 v[32:33], v10, s[16:19], s11 offen sc1
    s_mov_b64 exec, 1
    buffer_store_dword v34, off, s[16:19], s60 sc1
    s_branch Lpa_29
Lgu_31:
    s_mov_b32 s43, 0
    s_mov_b64 s[0:1], 0
    s_branch Lpk_30
Ls_32:
    buffer_store_dword v48, v13, s[16:19], s47 offen sc1
    s_branch Ls_33
Lgu_36:
    s_mov_b32 s43, 0
    s_mov_b64 s[0:1], 0
    s_branch Lpk_35
Ls_37:
    buffer_store_dwordx2 v[48:49], v11, s[16:19], s47 offen sc1
    s_branch Ls_38
Lca_41:
    v_lshlrev_b32 v55, 2, v0
    buffer_load_dword v54, v55, s[24:27], 0 offen sc1
    s_waitcnt vmcnt(0)
    s_nop 1
    v_add_u32_dpp v54, v54, v54 row_ror:1 row_mask:0xf bank_mask:0xf
    s_nop 1
    v_add_u32_dpp v54, v54, v54 row_ror:2 row_mask:0xf bank_mask:0xf
    s_nop 1
    v_add_u32_dpp v54, v54, v54 row_ror:4 row_mask:0xf bank_mask:0xf
    s_nop 1
    v_add_u32_dpp v54, v54, v54 row_ror:8 row_mask:0xf bank_mask:0xf
    v_mov_b32 v15, v54
    s_nop 1
    v_permlane16_swap_b32 v54, v15
    v_add_u32 v54, v54, v15
    v_mov_b32 v15, v54
    s_nop 1
    v_permlane32_swap_b32 v54, v15
    v_add_u32 v54, v54, v15
    s_nop 0
    v_readfirstlane_b32 s47, v54
    s_nop 3
    s_cmp_ge_u32 s47, 256
    s_cbranch_scc1 Lcad_42
    s_cmp_eq_u32 s43, 0
    s_cbranch_scc1 Lcad_42
    s_sub_u32 s43, s43, 1
    s_sleep 8
    s_branch Lca_41
Lgu_45:
    s_mov_b32 s43, 0
    s_mov_b64 s[0:1], 0
    s_branch Lpk_44
Lgu_47:
    s_mov_b32 s43, 0
    s_mov_b64 s[0:1], 0
    s_branch Lpk_46
Ls_48:
    buffer_store_dword v48, v11, s[16:19], s47 offen sc1
    s_branch Ls_49
Lgu_52:
    s_mov_b32 s43, 0
    s_mov_b64 s[0:1], 0
    s_branch Lpk_51
Ls_53:
    buffer_store_dword v48, v11, s[16:19], s47 offen sc1
    s_branch Ls_54
Lgu_59:
    s_mov_b32 s43, 0
    s_mov_b64 s[0:1], 0
    s_branch Lpk_58
Lgu_62:
    s_mov_b32 s43, 0
    s_mov_b64 s[0:1], 0
    s_branch Lpk_61
Ls_63:
    buffer_store_dword v48, v11, s[16:19], s46 offen sc1
    s_branch Ls_64
L_LAST:
.section .rodata,"a"
.p2align 6
.amdhsa_kernel interleave_layers__gqa_block_cached__glu_gated_reglu__decode_kernel
  .amdhsa_next_free_vgpr 512
  .amdhsa_next_free_sgpr 102
  .amdhsa_accum_offset 256
  .amdhsa_group_segment_fixed_size 0
  .amdhsa_kernarg_size 96
  .amdhsa_user_sgpr_count 2
  .amdhsa_user_sgpr_kernarg_segment_ptr 1
  .amdhsa_system_sgpr_workgroup_id_x 1
.end_amdhsa_kernel
```
